```python
import torch

def _softmax(x, axis=-1):
    return torch.softmax(x, dim=axis)
def _gelu(x):
    return torch.nn.functional.gelu(x, approximate="tanh")
def _silu(x):
    return torch.nn.functional.silu(x)
def _sigmoid(x):
    return torch.sigmoid(x)
def _layernorm(x, axis=-1, eps=1e-5):
    m = x.mean(dim=axis, keepdim=True)
    v = x.var(dim=axis, keepdim=True, unbiased=False)
    return (x - m) / torch.sqrt(v + eps)
def _scatter_add(tgt, idx, src, axis=0):
    return tgt.clone().index_add_(axis, idx, src)
def _segment_sum(src, seg, n):
    out = torch.zeros((n,) + src.shape[1:], dtype=src.dtype)
    return out.index_add_(0, seg, src)
def _pad(x, pw):
    flat = tuple(v for pair in reversed(pw) for v in pair)
    return torch.nn.functional.pad(x, flat)

kernel_name = 'parallel_sum__ssm_conv_s4__mixer_channel_mlp__prompt'

def setup_inputs():

    _w = (lambda a: (lambda t: t.to(torch.bfloat16) if t.is_floating_point() else t)(torch.as_tensor(a)))
    def _A_setup():
        B, L, D, N = 1, 2048, 640, 192
        A_re = -(lambda _x: torch.exp(torch.as_tensor(_x)))((lambda *s: torch.randn(*s, dtype=torch.bfloat16) * 3.2)(D, N))
        A_im = torch.pi * (lambda *s: torch.randn(*s, dtype=torch.bfloat16) * 0.05)(D, N)
        B_re = (lambda *s: torch.randn(*s, dtype=torch.bfloat16) * 0.1)(D, N)
        B_im = (lambda *s: torch.randn(*s, dtype=torch.bfloat16) * 0.1)(D, N)
        C_re = (lambda *s: torch.randn(*s, dtype=torch.bfloat16) * 0.1)(D, N)
        C_im = (lambda *s: torch.randn(*s, dtype=torch.bfloat16) * 0.1)(D, N)
        log_dt = (lambda *s: torch.randn(*s, dtype=torch.bfloat16) * 0.05)(D) * 0.5 - 4.0
        Dskip = (lambda *s: torch.randn(*s, dtype=torch.bfloat16) * 0.05)(D)
        return {
            "u": _w((lambda *s: torch.randn(*s, dtype=torch.bfloat16) * 0.05)(B, L, D)),
            "A_re": _w(A_re),
            "A_im": _w(A_im),
            "B_re": _w(B_re),
            "B_im": _w(B_im),
            "C_re": _w(C_re),
            "C_im": _w(C_im),
            "log_dt": _w(log_dt),
            "Dskip": _w(Dskip),
        }
    _A_in = _A_setup()

    def _B_setup():
        B, S, D, F = 1, 2048, 640, 1536
        return {
            "x": _w((lambda *s: torch.randn(*s, dtype=torch.bfloat16) * 0.05)(B, S, D)),
            "w1": _w((lambda *s: torch.randn(*s, dtype=torch.bfloat16) * 1.6)(D, F) * (D ** -0.5)),
            "b1": _w((lambda *s: torch.randn(*s, dtype=torch.bfloat16) * 0.8)(F)),
            "w2": _w((lambda *s: torch.randn(*s, dtype=torch.bfloat16) * 0.05)(F, D) * (F ** -0.5)),
            "b2": _w((lambda *s: torch.randn(*s, dtype=torch.bfloat16) * 0.05)(D)),
        }
    _B_in = _B_setup()

    return {
        "A_u": _A_in["u"],
        "A_A_re": _A_in["A_re"],
        "A_A_im": _A_in["A_im"],
        "A_B_re": _A_in["B_re"],
        "A_B_im": _A_in["B_im"],
        "A_C_re": _A_in["C_re"],
        "A_C_im": _A_in["C_im"],
        "A_log_dt": _A_in["log_dt"],
        "A_Dskip": _A_in["Dskip"],
        "B_x": _B_in["x"],
        "B_w1": _B_in["w1"],
        "B_b1": _B_in["b1"],
        "B_w2": _B_in["w2"],
        "B_b2": _B_in["b2"],
    }

def reference(A_u, A_A_re, A_A_im, A_B_re, A_B_im, A_C_re, A_C_im, A_log_dt, A_Dskip, B_x, B_w1, B_b1, B_w2, B_b2):
    def _A_ref(u, A_re, A_im, B_re, B_im, C_re, C_im, log_dt, Dskip):
        Bsz, L, D = u.shape
        dt = torch.exp(log_dt)[:, None]
        A = A_re + 1j * A_im
        Bc = B_re + 1j * B_im
        Cc = C_re + 1j * C_im
        logdA = dt * A
        dB = dt * Bc
        l = (lambda x, dt: x.to(dt))(torch.arange(L), A_re.dtype)
        P = torch.exp(logdA[:, :, None] * l[None, None, :])
        K = torch.einsum("dn,dnl,dn->dl", Cc, P, dB).real
        L2 = 2 * L
        Kp = _pad(K, ((0, 0), (0, L)))
        up = (lambda x, *d: x.permute(*d))(u, 0, 2, 1)
        up = _pad(up, ((0, 0), (0, 0), (0, L)))
        Kf = (lambda x, axes=(-2,-1): torch.fft.rfft2(x.float(), dim=axes))(Kp[:, None, :], axes=(-2, -1))
        Uf = (lambda x, axes=(-2,-1): torch.fft.rfft2(x.float(), dim=axes))(up[:, :, None, :], axes=(-2, -1))
        Yf = Uf * Kf[None, :, :, :]
        y = (lambda x, s, axes=(-2,-1): torch.fft.irfft2(x, s=s, dim=axes).to(torch.bfloat16))(Yf, (1, L2), axes=(-2, -1))[:, :, 0, :L]
        y = (lambda x, *d: x.permute(*d))(y, 0, 2, 1) + u * Dskip[None, None, :]
        return y

    def _B_ref(x, w1, b1, w2, b2):
        y = _layernorm(x, axis=-1)
        h = _gelu(torch.einsum("bsd,df->bsf", y, w1) + b1)
        return torch.einsum("bsf,fd->bsd", h, w2) + b2

    x = A_u
    xn = _layernorm(x, axis=-1)
    return x + _A_ref(xn, A_A_re, A_A_im, A_B_re, A_B_im, A_C_re, A_C_im, A_log_dt, A_Dskip) + _B_ref(xn, B_w1, B_b1, B_w2, B_b2)
```

```asm
; @launch grid=(256,1,1) block=(512,1,1) lds=163840
.amdgcn_target "amdgcn-amd-amdhsa--gfx950"
.text
.globl parallel_sum__ssm_conv_s4__mixer_channel_mlp__prompt_kernel
.p2align 8
.type parallel_sum__ssm_conv_s4__mixer_channel_mlp__prompt_kernel,@function
parallel_sum__ssm_conv_s4__mixer_channel_mlp__prompt_kernel:
    s_cmp_ge_u32 s2, 256
    s_cbranch_scc1 k_end
    s_load_dwordx2 s[4:5], s[0:1], 0
    s_load_dwordx16 s[32:47], s[0:1], 8
    s_load_dwordx2 s[8:9], s[0:1], 80
    s_load_dwordx2 s[16:17], s[0:1], 96
    s_load_dwordx2 s[12:13], s[0:1], 128
    s_getpc_b64 s[74:75]
    s_bfe_u32 s60, s2, 0x30003
    v_lshrrev_b32 v2, 3, v0
    v_lshl_add_u32 v2, v2, 3, s60
    v_lshlrev_b32 v2, 7, v2
    v_min_u32 v2, 0x8890, v2
    global_load_dword v231, v2, s[74:75]
    v_lshrrev_b32 v1, 6, v0
    v_and_b32 v0, 63, v0
    v_readfirstlane_b32 s77, v1
    v_lshlrev_b32 v248, 4, v0
    v_lshrrev_b32 v250, 4, v0
    v_and_b32 v251, 15, v0
    s_lshr_b32 s50, s2, 5
    s_bfe_u32 s51, s2, 0x20003
    s_bfe_u32 s48, s2, 0x20001
    s_lshl3_add_u32 s48, s48, s50
    s_and_b32 s49, s2, 1
    s_lshl2_add_u32 s49, s49, s51
    s_and_b32 s3, s77, 3
    s_cmp_ge_u32 s2, 160
    s_cbranch_scc1 role_a
    s_cmp_lt_u32 s77, 4
    s_cbranch_scc1 role_c
role_h:
    s_and_b32 s60, s2, 0xf0
    s_and_b32 s61, s2, 7
    s_lshl1_add_u32 s60, s61, s60
    s_bfe_u32 s61, s2, 0x10003
    s_add_u32 s59, s60, s61
    s_lshl2_add_u32 s56, s59, s3
    s_mul_i32 s60, s56, 384
    v_add_u32 v21, s60, v248
    s_mul_i32 s58, s3, 2304
    s_lshl_b32 s76, s56, 1
    s_and_b32 s76, s76, 0x7fc
    s_mov_b64 exec, 0xffffff
    s_add_u32 m0, s58, 34688
    s_waitcnt lgkmcnt(0)
    global_load_lds_dwordx4 v21, s[32:33]
    s_add_u32 m0, s58, 35072
    s_nop 0
    global_load_lds_dwordx4 v21, s[34:35]
    s_add_u32 m0, s58, 35456
    s_nop 0
    global_load_lds_dwordx4 v21, s[36:37]
    s_add_u32 m0, s58, 35840
    s_nop 0
    global_load_lds_dwordx4 v21, s[38:39]
    s_add_u32 m0, s58, 36224
    s_nop 0
    global_load_lds_dwordx4 v21, s[40:41]
    s_add_u32 m0, s58, 36608
    s_nop 0
    global_load_lds_dwordx4 v21, s[42:43]
    s_mov_b64 exec, -1
    s_load_dword s79, s[44:45], s76
    s_load_dword s77, s[46:47], s76
    s_lshr_b32 s60, s2, 1
    s_min_u32 s60, s60, 63
    s_lshr_b32 s61, s3, 1
    s_mul_i32 s61, s61, 320
    s_add_u32 s60, s60, s61
    s_and_b32 s61, s2, 1
    s_mul_i32 s61, s61, 258
    s_lshl2_add_u32 s60, s60, s61
    s_and_b32 s61, s3, 1
    s_add_u32 s60, s60, s61
    s_add_u32 s60, s60, 768
    s_mul_i32 s60, s60, 768
    v_lshl_add_u32 v22, v0, 7, s60
    s_mov_b64 exec, 0x3f
    global_load_dword v23, v22, s[8:9]
    s_mov_b64 exec, -1
    s_barrier
    s_load_dwordx2 s[16:17], s[0:1], 112
    s_load_dwordx2 s[24:25], s[0:1], 104
    s_load_dwordx2 s[28:29], s[0:1], 120
    s_mov_b32 s6, 0x280000
    s_mov_b32 s7, 0x20000
    s_mov_b32 s14, 0xd80000
    s_mov_b32 s15, 0x20000
    s_mov_b32 s18, 0x280000
    s_mov_b32 s19, 0x20000
    s_mov_b32 s26, 0x500
    s_mov_b32 s27, 0x20000
    s_mov_b32 s30, 0x100
    s_mov_b32 s31, 0x20000
    s_mul_i32 s70, s3, 4096
    v_mov_b32 v227, 3584
    v_mov_b32 v245, 1
    s_movk_i32 s75, 128
    s_and_b32 s74, s2, 7
    s_lshl_b32 s74, s74, 8
    v_lshl_add_u32 v2, v0, 2, s74
    v_mov_b32 v84, 0
    v_mov_b32 v85, 0
    v_mov_b32 v86, 0
    v_mov_b32 v87, 0
    s_cmp_lg_u32 s56, 3
    s_cbranch_scc1 ini_1
    v_lshlrev_b32 v253, 8, v0
    s_mov_b64 exec, 0xffff
    buffer_store_dwordx2 v[84:85], v253, s[12:15], 0 offen sc1
    s_waitcnt vmcnt(0)
    s_mov_b64 exec, 1
    s_waitcnt lgkmcnt(0)
    buffer_store_dword v245, off, s[28:31], 0 sc1
    s_mov_b64 exec, -1
ini_1:
    s_add_u32 s60, s58, 34688
    v_lshl_add_u32 v20, v0, 1, s60
    s_mul_i32 s58, s3, 4576
    s_add_u32 s58, s58, 16384
    v_add_u32 v240, s70, v248
    v_add_u32 v252, s58, v248
    ds_write_b128 v240, v[84:87] offset:0
    ds_write_b128 v240, v[84:87] offset:1024
    ds_write_b128 v240, v[84:87] offset:2048
    ds_write_b128 v240, v[84:87] offset:3072
    s_mov_b64 exec, 0x3fffffff
    ds_write_b128 v252, v[84:87]
    s_mov_b64 exec, -1
    v_lshrrev_b32 v247, 5, v0
    v_and_b32 v246, 31, v0
    s_mul_i32 s57, s3, 15232
    v_mov_b32 v110, 0
    v_mov_b32 v111, 0
    v_mov_b32 v112, 0
    v_mov_b32 v113, 0
    v_mov_b32 v114, 0
    v_mov_b32 v115, 0
    v_mov_b32 v116, 0
    v_mov_b32 v117, 0
    v_mov_b32 v118, 0
    v_mov_b32 v119, 0
    v_mov_b32 v120, 0
    v_mov_b32 v121, 0
    v_mov_b32 v122, 0
    v_mov_b32 v123, 0
    v_mov_b32 v124, 0
    v_mov_b32 v125, 0
    v_mov_b32 v126, 0
    v_mov_b32 v127, 0
    s_lshr_b32 s66, s59, 1
    s_lshl2_add_u32 s66, s66, s3
    s_lshl_b32 s66, s66, 13
    s_and_b32 s60, s59, 1
    s_lshl_b32 s60, s60, 6
    s_add_u32 s66, s66, s60
    s_add_u32 s66, s66, 0x10000
    s_add_u32 s67, s66, 4096
    v_and_b32 v241, 60, v0
    v_add_lshl_u32 v241, v241, v0, 4
    v_sub_u32 v252, 63, v0
    v_lshl_add_u32 v239, v252, 4, s70
    v_lshl_add_u32 v243, v252, 2, s70
    v_lshrrev_b32 v252, 1, v252
    v_lshl_add_u32 v244, v252, 2, s70
    v_and_b32 v252, 3, v0
    v_mul_u32_u24 v252, 4576, v252
    v_lshrrev_b32 v253, 2, v0
    v_lshl_add_u32 v252, v253, 4, v252
    s_lshl_b32 s60, s3, 10
    s_add_u32 s60, s60, 16864
    v_add_u32 v242, s60, v252
    v_lshlrev_b32 v252, 3, v250
    v_sub_u32 v254, v252, v251
    v_add_u32 v252, 16, v254
    v_lshrrev_b32 v252, 1, v252
    v_and_b32 v253, 1, v0
    v_xor_b32 v253, 1, v253
    v_mul_u32_u24 v253, 1216, v253
    v_lshl_add_u32 v252, v252, 2, v253
    v_add_u32 v232, s70, v252
    v_add_u32 v233, 512, v232
    v_lshlrev_b32 v252, 5, v251
    v_lshl_add_u32 v252, v250, 4, v252
    v_add_u32 v234, s58, v252
    v_lshlrev_b32 v252, 2, v250
    v_sub_u32 v252, v252, v251
    v_add_u32 v252, 15, v252
    s_add_u32 s60, s70, 2368
    v_lshl_add_u32 v236, v252, 2, s60
    s_add_u32 s60, s70, 2688
    v_lshl_add_u32 v235, v252, 3, s60
    v_add_u32 v254, 15, v254
    v_min_u32 v237, 31, v254
    v_mul_u32_u24 v252, 272, v246
    v_subrev_u32 v253, 16, v246
    v_lshl_add_u32 v252, v247, 4, v252
    v_cmp_lt_u32 vcc, 24, v246
    v_add_u32 v225, s57, v252
    s_nop 0
    v_cndmask_b32 v253, v246, v253, vcc
    v_writelane_b32 v253, 4, 5
    v_writelane_b32 v253, 4, 37
    v_writelane_b32 v253, 12, 7
    v_writelane_b32 v253, 12, 39
    v_writelane_b32 v253, 12, 13
    v_writelane_b32 v253, 12, 45
    v_writelane_b32 v253, 13, 24
    v_writelane_b32 v253, 13, 56
    v_mul_u32_u24 v252, 272, v253
    v_lshl_add_u32 v252, v247, 4, v252
    v_add_u32 v224, s57, v252
    s_mov_b32 s62, 0x3e00000
    v_lshrrev_b32_e64 v254, v237, s62
    v_and_b32 v254, 0xff, v254
    v_lshl_or_b32 v254, v254, 15, v254
    v_lshrrev_b32 v205, 2, v254
    v_lshrrev_b32 v206, 4, v254
    s_waitcnt lgkmcnt(0)
    s_lshl_b32 s76, s79, 16
    s_and_b32 s79, s79, 0xffff0000
    s_bitcmp1_b32 s56, 0
    s_cselect_b32 s79, s79, s76
    v_mov_b32 v137, 0x3fb8aa3b
    v_mul_f32 v137, s79, v137
    v_exp_f32 v137, v137
    s_nop 0
    v_cvt_pk_bf16_f32 v137, v137, v137
    v_and_b32 v137, 0xffff0000, v137
    s_lshl_b32 s76, s77, 16
    s_and_b32 s77, s77, 0xffff0000
    s_bitcmp1_b32 s56, 0
    s_cselect_b32 s77, s77, s76
    v_mov_b32 v238, s77
    v_mul_f32 v135, 0x3fb8aa3b, v137
    v_mul_f32 v136, 0x3e22f983, v137
    s_waitcnt vmcnt(1)
    ds_read_u16_d16_hi v112, v20 offset:768
    ds_read_u16_d16_hi v118, v20 offset:896
    ds_read_u16_d16_hi v124, v20 offset:1024
    ds_read_u16_d16_hi v114, v20 offset:1536
    ds_read_u16_d16_hi v120, v20 offset:1664
    ds_read_u16_d16_hi v126, v20 offset:1792
    ds_read_u16_d16_hi v115, v20 offset:1920
    ds_read_u16_d16_hi v121, v20 offset:2048
    ds_read_u16_d16_hi v127, v20 offset:2176
    ds_read_u16_d16_hi v113, v20 offset:1152
    ds_read_u16_d16_hi v119, v20 offset:1280
    ds_read_u16_d16_hi v125, v20 offset:1408
    ds_read_u16_d16_hi v110, v20 offset:0
    ds_read_u16_d16_hi v116, v20 offset:128
    ds_read_u16_d16_hi v122, v20 offset:256
    ds_read_u16_d16_hi v111, v20 offset:384
    ds_read_u16_d16_hi v117, v20 offset:512
    ds_read_u16_d16_hi v123, v20 offset:640
    s_waitcnt lgkmcnt(14)
    v_mul_f32 v128, v112, v114
    s_waitcnt lgkmcnt(11)
    v_mul_f32 v129, v112, v115
    v_mul_f32 v130, v118, v120
    s_waitcnt lgkmcnt(10)
    v_mul_f32 v131, v118, v121
    v_mul_f32 v132, v124, v126
    s_waitcnt lgkmcnt(9)
    v_mul_f32 v133, v124, v127
    s_waitcnt lgkmcnt(8)
    v_fma_f32 v128, -v113, v115, v128
    v_fmac_f32 v129, v113, v114
    s_waitcnt lgkmcnt(7)
    v_fma_f32 v130, -v119, v121, v130
    v_fmac_f32 v131, v119, v120
    s_waitcnt lgkmcnt(6)
    v_fma_f32 v132, -v125, v127, v132
    v_fmac_f32 v133, v125, v126
    v_max3_f32 v134, abs(v128), abs(v129), abs(v130)
    v_max3_f32 v252, abs(v131), abs(v132), abs(v133)
    v_max_f32 v134, v134, v252
    s_waitcnt lgkmcnt(5)
    v_mul_f32 v110, v110, v135
    s_waitcnt lgkmcnt(2)
    v_mul_f32 v111, v111, v136
    v_mul_f32 v116, v116, v135
    v_max_f32_dpp v134, v134, v134 row_ror:8 row_mask:0xf bank_mask:0xf
    s_waitcnt lgkmcnt(1)
    v_mul_f32 v117, v117, v136
    v_mul_f32 v122, v122, v135
    s_waitcnt lgkmcnt(0)
    v_mul_f32 v123, v123, v136
    v_max_f32_dpp v134, v134, v134 row_ror:4 row_mask:0xf bank_mask:0xf
    v_mul_f32 v112, 0x43800000, v110
    v_mul_f32 v113, 0x43800000, v111
    v_mul_f32 v114, 0x41000000, v110
    v_max_f32_dpp v134, v134, v134 row_ror:2 row_mask:0xf bank_mask:0xf
    v_mul_f32 v115, 0x41000000, v111
    v_mul_f32 v118, 0x43800000, v116
    v_mul_f32 v119, 0x43800000, v117
    v_max_f32_dpp v134, v134, v134 row_ror:1 row_mask:0xf bank_mask:0xf
    v_mov_b32 v252, v134
    v_mul_f32 v120, 0x41000000, v116
    v_mul_f32 v121, 0x41000000, v117
    v_mul_f32 v124, 0x43800000, v122
    v_permlane16_swap_b32 v134, v252
    v_max_f32 v134, v134, v252
    v_mov_b32 v252, v134
    v_mul_f32 v125, 0x43800000, v123
    v_mul_f32 v126, 0x41000000, v122
    v_mul_f32 v127, 0x41000000, v123
    v_permlane32_swap_b32 v134, v252
    v_max_f32 v134, v134, v252
    v_frexp_exp_i32_f32 v134, v134
    v_sub_u32 v252, 5, v134
    v_subrev_u32 v134, 5, v134
    v_ldexp_f32 v128, v128, v252
    v_ldexp_f32 v129, v129, v252
    v_ldexp_f32 v130, v130, v252
    v_ldexp_f32 v131, v131, v252
    v_ldexp_f32 v132, v132, v252
    v_ldexp_f32 v133, v133, v252
    v_ldexp_f32 v226, v137, v134
    v_cvt_pk_f16_f32 v4, v128, -v129
    v_cvt_pk_f16_f32 v100, v130, -v131
    v_cvt_pk_f16_f32 v152, v132, -v133
    v_fract_f32 v165, v111
    v_exp_f32 v164, v110
    v_fract_f32 v171, v113
    v_exp_f32 v170, v112
    v_fract_f32 v177, v115
    v_exp_f32 v176, v114
    v_cos_f32 v160, v165
    v_sin_f32 v161, v165
    v_cos_f32 v166, v171
    v_sin_f32 v167, v171
    v_cos_f32 v172, v177
    v_sin_f32 v173, v177
    v_mul_f32 v160, v160, v164
    v_mul_f32 v161, v161, v164
    v_mul_f32 v166, v166, v170
    v_mul_f32 v167, v167, v170
    v_mul_f32 v172, v172, v176
    v_mul_f32 v173, v173, v176
    v_add_f32 v165, v160, v160
    v_mul_f32 v164, v161, v161
    v_add_f32 v171, v166, v166
    v_mul_f32 v170, v167, v167
    v_add_f32 v177, v172, v172
    v_mul_f32 v176, v173, v173
    v_cvt_pk_f16_f32 v56, v160, -v161
    v_cvt_pk_f16_f32 v59, v166, -v167
    v_cvt_pk_f16_f32 v51, v172, v173
    v_fma_f32 v162, v160, v160, -v164
    v_mul_f32 v163, v165, v161
    v_fma_f32 v168, v166, v166, -v170
    v_mul_f32 v169, v171, v167
    v_fma_f32 v174, v172, v172, -v176
    v_mul_f32 v175, v177, v173
    v_add_f32 v165, v162, v162
    v_mul_f32 v164, v163, v163
    v_add_f32 v171, v168, v168
    v_mul_f32 v170, v169, v169
    v_add_f32 v177, v174, v174
    v_mul_f32 v176, v175, v175
    v_cvt_pk_f16_f32 v57, v162, -v163
    v_cvt_pk_f16_f32 v60, v168, -v169
    v_cvt_pk_f16_f32 v52, v174, v175
    v_fma_f32 v160, v162, v162, -v164
    v_mul_f32 v161, v165, v163
    v_fma_f32 v166, v168, v168, -v170
    v_mul_f32 v167, v171, v169
    v_fma_f32 v172, v174, v174, -v176
    v_mul_f32 v173, v177, v175
    v_add_f32 v171, v166, v166
    v_mul_f32 v170, v167, v167
    v_add_f32 v177, v172, v172
    v_mul_f32 v176, v173, v173
    v_cvt_pk_f16_f32 v58, v160, -v161
    v_cvt_pk_f16_f32 v61, v166, -v167
    v_cvt_pk_f16_f32 v53, v172, v173
    v_fma_f32 v168, v166, v166, -v170
    v_mul_f32 v169, v171, v167
    v_fma_f32 v174, v172, v172, -v176
    v_mul_f32 v175, v177, v173
    v_add_f32 v177, v174, v174
    v_mul_f32 v176, v175, v175
    v_cvt_pk_f16_f32 v62, v168, -v169
    v_cvt_pk_f16_f32 v54, v174, v175
    v_fma_f32 v172, v174, v174, -v176
    v_mul_f32 v173, v177, v175
    v_cvt_pk_f16_f32 v55, v172, v173
    v_fract_f32 v165, v117
    v_exp_f32 v164, v116
    v_fract_f32 v171, v119
    v_exp_f32 v170, v118
    v_fract_f32 v177, v121
    v_exp_f32 v176, v120
    v_cos_f32 v160, v165
    v_sin_f32 v161, v165
    v_cos_f32 v166, v171
    v_sin_f32 v167, v171
    v_cos_f32 v172, v177
    v_sin_f32 v173, v177
    v_mul_f32 v160, v160, v164
    v_mul_f32 v161, v161, v164
    v_mul_f32 v166, v166, v170
    v_mul_f32 v167, v167, v170
    v_mul_f32 v172, v172, v176
    v_mul_f32 v173, v173, v176
    v_add_f32 v165, v160, v160
    v_mul_f32 v164, v161, v161
    v_add_f32 v171, v166, v166
    v_mul_f32 v170, v167, v167
    v_add_f32 v177, v172, v172
    v_mul_f32 v176, v173, v173
    v_cvt_pk_f16_f32 v63, v160, -v161
    v_cvt_pk_f16_f32 v66, v166, -v167
    v_cvt_pk_f16_f32 v147, v172, v173
    v_fma_f32 v162, v160, v160, -v164
h_g1:
    s_barrier
    v_mul_f32 v163, v165, v161
    v_fma_f32 v168, v166, v166, -v170
    v_mul_f32 v169, v171, v167
    v_fma_f32 v174, v172, v172, -v176
    v_mul_f32 v175, v177, v173
    v_add_f32 v165, v162, v162
    v_mul_f32 v164, v163, v163
    v_add_f32 v171, v168, v168
    v_mul_f32 v170, v169, v169
    v_add_f32 v177, v174, v174
    v_mul_f32 v176, v175, v175
    v_cvt_pk_f16_f32 v64, v162, -v163
    v_cvt_pk_f16_f32 v67, v168, -v169
    v_cvt_pk_f16_f32 v148, v174, v175
    v_fma_f32 v160, v162, v162, -v164
    v_mul_f32 v161, v165, v163
    v_fma_f32 v166, v168, v168, -v170
    v_mul_f32 v167, v171, v169
    v_fma_f32 v172, v174, v174, -v176
    v_mul_f32 v173, v177, v175
    v_add_f32 v171, v166, v166
    v_mul_f32 v170, v167, v167
    v_add_f32 v177, v172, v172
    v_mul_f32 v176, v173, v173
    v_cvt_pk_f16_f32 v65, v160, -v161
    v_cvt_pk_f16_f32 v68, v166, -v167
    v_cvt_pk_f16_f32 v149, v172, v173
    v_fma_f32 v168, v166, v166, -v170
    v_mul_f32 v169, v171, v167
    v_fma_f32 v174, v172, v172, -v176
    v_mul_f32 v175, v177, v173
    v_add_f32 v177, v174, v174
    v_mul_f32 v176, v175, v175
    v_cvt_pk_f16_f32 v69, v168, -v169
    v_cvt_pk_f16_f32 v150, v174, v175
    v_fma_f32 v172, v174, v174, -v176
    s_barrier
    v_mul_f32 v173, v177, v175
    v_cvt_pk_f16_f32 v151, v172, v173
    v_fract_f32 v165, v123
    v_exp_f32 v164, v122
    v_fract_f32 v171, v125
    v_exp_f32 v170, v124
    v_fract_f32 v177, v127
    v_exp_f32 v176, v126
    v_cos_f32 v160, v165
    v_sin_f32 v161, v165
    v_cos_f32 v166, v171
    v_sin_f32 v167, v171
    v_cos_f32 v172, v177
    v_sin_f32 v173, v177
    v_mul_f32 v160, v160, v164
    v_mul_f32 v161, v161, v164
    v_mul_f32 v166, v166, v170
    v_mul_f32 v167, v167, v170
    v_mul_f32 v172, v172, v176
    v_mul_f32 v173, v173, v176
    v_add_f32 v165, v160, v160
    v_mul_f32 v164, v161, v161
    v_add_f32 v171, v166, v166
    v_mul_f32 v170, v167, v167
    v_add_f32 v177, v172, v172
    v_mul_f32 v176, v173, v173
    v_cvt_pk_f16_f32 v70, v160, -v161
    v_cvt_pk_f16_f32 v73, v166, -v167
    v_cvt_pk_f16_f32 v199, v172, v173
    v_fma_f32 v162, v160, v160, -v164
    v_mul_f32 v163, v165, v161
    v_fma_f32 v168, v166, v166, -v170
    v_mul_f32 v169, v171, v167
    v_fma_f32 v174, v172, v172, -v176
    v_mul_f32 v175, v177, v173
    v_add_f32 v165, v162, v162
    s_barrier
    v_mul_f32 v164, v163, v163
    v_add_f32 v171, v168, v168
    v_mul_f32 v170, v169, v169
    v_add_f32 v177, v174, v174
    v_mul_f32 v176, v175, v175
    v_cvt_pk_f16_f32 v71, v162, -v163
    v_cvt_pk_f16_f32 v74, v168, -v169
    v_cvt_pk_f16_f32 v200, v174, v175
    v_fma_f32 v160, v162, v162, -v164
    v_mul_f32 v161, v165, v163
    v_fma_f32 v166, v168, v168, -v170
    v_mul_f32 v167, v171, v169
    v_fma_f32 v172, v174, v174, -v176
    v_mul_f32 v173, v177, v175
    v_add_f32 v171, v166, v166
    v_mul_f32 v170, v167, v167
    v_add_f32 v177, v172, v172
    v_mul_f32 v176, v173, v173
    v_cvt_pk_f16_f32 v72, v160, -v161
    v_cvt_pk_f16_f32 v75, v166, -v167
    v_cvt_pk_f16_f32 v201, v172, v173
    v_fma_f32 v168, v166, v166, -v170
    v_mul_f32 v169, v171, v167
    v_fma_f32 v174, v172, v172, -v176
    v_mul_f32 v175, v177, v173
    v_add_f32 v177, v174, v174
    v_mul_f32 v176, v175, v175
    v_cvt_pk_f16_f32 v76, v168, -v169
    v_cvt_pk_f16_f32 v202, v174, v175
    v_fma_f32 v172, v174, v174, -v176
    v_mul_f32 v173, v177, v175
    v_cvt_pk_f16_f32 v203, v172, v173
    v_pk_mul_f16 v5, v4, v56 op_sel_hi:[1,0]
    v_pk_mul_f16 v6, v4, v57 op_sel_hi:[1,0]
    v_pk_fma_f16 v5, v4, v56, v5 op_sel:[1,1,0] op_sel_hi:[0,1,1] neg_lo:[1,0,0]
    v_pk_fma_f16 v6, v4, v57, v6 op_sel:[1,1,0] op_sel_hi:[0,1,1] neg_lo:[1,0,0]
    s_barrier
    v_pk_mul_f16 v7, v5, v57 op_sel_hi:[1,0]
    v_pk_mul_f16 v8, v4, v58 op_sel_hi:[1,0]
    v_pk_fma_f16 v7, v5, v57, v7 op_sel:[1,1,0] op_sel_hi:[0,1,1] neg_lo:[1,0,0]
    v_pk_fma_f16 v8, v4, v58, v8 op_sel:[1,1,0] op_sel_hi:[0,1,1] neg_lo:[1,0,0]
    v_pk_mul_f16 v9, v5, v58 op_sel_hi:[1,0]
    v_pk_mul_f16 v10, v6, v58 op_sel_hi:[1,0]
    v_pk_fma_f16 v9, v5, v58, v9 op_sel:[1,1,0] op_sel_hi:[0,1,1] neg_lo:[1,0,0]
    v_pk_fma_f16 v10, v6, v58, v10 op_sel:[1,1,0] op_sel_hi:[0,1,1] neg_lo:[1,0,0]
    v_pk_mul_f16 v11, v7, v58 op_sel_hi:[1,0]
    v_pk_mul_f16 v12, v4, v59 op_sel_hi:[1,0]
    v_pk_fma_f16 v11, v7, v58, v11 op_sel:[1,1,0] op_sel_hi:[0,1,1] neg_lo:[1,0,0]
    v_pk_fma_f16 v12, v4, v59, v12 op_sel:[1,1,0] op_sel_hi:[0,1,1] neg_lo:[1,0,0]
    v_pk_mul_f16 v13, v4, v60 op_sel_hi:[1,0]
    v_pk_mul_f16 v14, v12, v60 op_sel_hi:[1,0]
    v_pk_fma_f16 v13, v4, v60, v13 op_sel:[1,1,0] op_sel_hi:[0,1,1] neg_lo:[1,0,0]
    v_pk_fma_f16 v14, v12, v60, v14 op_sel:[1,1,0] op_sel_hi:[0,1,1] neg_lo:[1,0,0]
    v_pk_mul_f16 v15, v4, v61 op_sel_hi:[1,0]
    v_pk_mul_f16 v16, v12, v61 op_sel_hi:[1,0]
    v_pk_fma_f16 v15, v4, v61, v15 op_sel:[1,1,0] op_sel_hi:[0,1,1] neg_lo:[1,0,0]
    v_pk_fma_f16 v16, v12, v61, v16 op_sel:[1,1,0] op_sel_hi:[0,1,1] neg_lo:[1,0,0]
    v_pk_mul_f16 v17, v13, v61 op_sel_hi:[1,0]
    v_pk_mul_f16 v18, v14, v61 op_sel_hi:[1,0]
    v_pk_fma_f16 v17, v13, v61, v17 op_sel:[1,1,0] op_sel_hi:[0,1,1] neg_lo:[1,0,0]
    v_pk_fma_f16 v18, v14, v61, v18 op_sel:[1,1,0] op_sel_hi:[0,1,1] neg_lo:[1,0,0]
    v_pk_mul_f16 v19, v4, v62 op_sel_hi:[1,0]
    v_pk_mul_f16 v20, v6, v59 op_sel_hi:[1,0]
    v_pk_fma_f16 v19, v4, v62, v19 op_sel:[1,1,0] op_sel_hi:[0,1,1] neg_lo:[1,0,0]
    v_pk_fma_f16 v20, v6, v59, v20 op_sel:[1,1,0] op_sel_hi:[0,1,1] neg_lo:[1,0,0]
    v_pk_mul_f16 v21, v8, v59 op_sel_hi:[1,0]
    v_pk_mul_f16 v22, v10, v59 op_sel_hi:[1,0]
    v_pk_fma_f16 v21, v8, v59, v21 op_sel:[1,1,0] op_sel_hi:[0,1,1] neg_lo:[1,0,0]
    v_pk_fma_f16 v22, v10, v59, v22 op_sel:[1,1,0] op_sel_hi:[0,1,1] neg_lo:[1,0,0]
    s_waitcnt vmcnt(0)
    v_pk_mul_f16 v23, v8, v60 op_sel_hi:[1,0]
    v_pk_mul_f16 v24, v21, v60 op_sel_hi:[1,0]
    v_pk_fma_f16 v23, v8, v60, v23 op_sel:[1,1,0] op_sel_hi:[0,1,1] neg_lo:[1,0,0]
    v_pk_fma_f16 v24, v21, v60, v24 op_sel:[1,1,0] op_sel_hi:[0,1,1] neg_lo:[1,0,0]
    s_barrier
    v_pk_mul_f16 v25, v51, v52 op_sel_hi:[1,0]
    v_pk_mul_f16 v26, v51, v53 op_sel_hi:[1,0]
    v_pk_fma_f16 v25, v51, v52, v25 op_sel:[1,1,0] op_sel_hi:[0,1,1] neg_lo:[1,0,0]
    v_pk_fma_f16 v26, v51, v53, v26 op_sel:[1,1,0] op_sel_hi:[0,1,1] neg_lo:[1,0,0]
    v_pk_mul_f16 v27, v52, v53 op_sel_hi:[1,0]
    v_pk_mul_f16 v28, v25, v53 op_sel_hi:[1,0]
    v_pk_fma_f16 v27, v52, v53, v27 op_sel:[1,1,0] op_sel_hi:[0,1,1] neg_lo:[1,0,0]
    v_pk_fma_f16 v28, v25, v53, v28 op_sel:[1,1,0] op_sel_hi:[0,1,1] neg_lo:[1,0,0]
    v_pk_mul_f16 v29, v51, v54 op_sel_hi:[1,0]
    v_pk_mul_f16 v30, v52, v54 op_sel_hi:[1,0]
    v_pk_fma_f16 v29, v51, v54, v29 op_sel:[1,1,0] op_sel_hi:[0,1,1] neg_lo:[1,0,0]
    v_pk_fma_f16 v30, v52, v54, v30 op_sel:[1,1,0] op_sel_hi:[0,1,1] neg_lo:[1,0,0]
    v_pk_mul_f16 v31, v25, v54 op_sel_hi:[1,0]
    v_pk_mul_f16 v32, v53, v54 op_sel_hi:[1,0]
    v_pk_fma_f16 v31, v25, v54, v31 op_sel:[1,1,0] op_sel_hi:[0,1,1] neg_lo:[1,0,0]
    v_pk_fma_f16 v32, v53, v54, v32 op_sel:[1,1,0] op_sel_hi:[0,1,1] neg_lo:[1,0,0]
    v_pk_mul_f16 v33, v26, v54 op_sel_hi:[1,0]
    v_pk_mul_f16 v34, v27, v54 op_sel_hi:[1,0]
    v_pk_fma_f16 v33, v26, v54, v33 op_sel:[1,1,0] op_sel_hi:[0,1,1] neg_lo:[1,0,0]
    v_pk_fma_f16 v34, v27, v54, v34 op_sel:[1,1,0] op_sel_hi:[0,1,1] neg_lo:[1,0,0]
    v_pk_mul_f16 v35, v28, v54 op_sel_hi:[1,0]
    v_pk_mul_f16 v36, v51, v55 op_sel_hi:[1,0]
    v_pk_fma_f16 v35, v28, v54, v35 op_sel:[1,1,0] op_sel_hi:[0,1,1] neg_lo:[1,0,0]
    v_pk_fma_f16 v36, v51, v55, v36 op_sel:[1,1,0] op_sel_hi:[0,1,1] neg_lo:[1,0,0]
    v_pk_mul_f16 v37, v52, v55 op_sel_hi:[1,0]
    v_pk_mul_f16 v38, v25, v55 op_sel_hi:[1,0]
    v_pk_fma_f16 v37, v52, v55, v37 op_sel:[1,1,0] op_sel_hi:[0,1,1] neg_lo:[1,0,0]
    v_pk_fma_f16 v38, v25, v55, v38 op_sel:[1,1,0] op_sel_hi:[0,1,1] neg_lo:[1,0,0]
    v_pk_mul_f16 v39, v53, v55 op_sel_hi:[1,0]
    v_pk_mul_f16 v40, v26, v55 op_sel_hi:[1,0]
    v_pk_fma_f16 v39, v53, v55, v39 op_sel:[1,1,0] op_sel_hi:[0,1,1] neg_lo:[1,0,0]
    v_pk_fma_f16 v40, v26, v55, v40 op_sel:[1,1,0] op_sel_hi:[0,1,1] neg_lo:[1,0,0]
    v_pk_mul_f16 v41, v27, v55 op_sel_hi:[1,0]
    v_pk_mul_f16 v42, v28, v55 op_sel_hi:[1,0]
    v_pk_fma_f16 v41, v27, v55, v41 op_sel:[1,1,0] op_sel_hi:[0,1,1] neg_lo:[1,0,0]
    v_pk_fma_f16 v42, v28, v55, v42 op_sel:[1,1,0] op_sel_hi:[0,1,1] neg_lo:[1,0,0]
    s_barrier
    v_pk_mul_f16 v43, v54, v55 op_sel_hi:[1,0]
    v_pk_mul_f16 v44, v29, v55 op_sel_hi:[1,0]
    v_pk_fma_f16 v43, v54, v55, v43 op_sel:[1,1,0] op_sel_hi:[0,1,1] neg_lo:[1,0,0]
    v_pk_fma_f16 v44, v29, v55, v44 op_sel:[1,1,0] op_sel_hi:[0,1,1] neg_lo:[1,0,0]
    v_pk_mul_f16 v45, v30, v55 op_sel_hi:[1,0]
    v_pk_mul_f16 v46, v31, v55 op_sel_hi:[1,0]
    v_pk_fma_f16 v45, v30, v55, v45 op_sel:[1,1,0] op_sel_hi:[0,1,1] neg_lo:[1,0,0]
    v_pk_fma_f16 v46, v31, v55, v46 op_sel:[1,1,0] op_sel_hi:[0,1,1] neg_lo:[1,0,0]
    v_pk_mul_f16 v47, v32, v55 op_sel_hi:[1,0]
    v_pk_mul_f16 v48, v33, v55 op_sel_hi:[1,0]
    v_pk_fma_f16 v47, v32, v55, v47 op_sel:[1,1,0] op_sel_hi:[0,1,1] neg_lo:[1,0,0]
    v_pk_fma_f16 v48, v33, v55, v48 op_sel:[1,1,0] op_sel_hi:[0,1,1] neg_lo:[1,0,0]
    v_pk_mul_f16 v49, v34, v55 op_sel_hi:[1,0]
    v_pk_mul_f16 v50, v35, v55 op_sel_hi:[1,0]
    v_pk_fma_f16 v49, v34, v55, v49 op_sel:[1,1,0] op_sel_hi:[0,1,1] neg_lo:[1,0,0]
    v_pk_fma_f16 v50, v35, v55, v50 op_sel:[1,1,0] op_sel_hi:[0,1,1] neg_lo:[1,0,0]
    v_pk_mul_f16 v101, v100, v63 op_sel_hi:[1,0]
    v_pk_mul_f16 v102, v100, v64 op_sel_hi:[1,0]
    v_pk_fma_f16 v101, v100, v63, v101 op_sel:[1,1,0] op_sel_hi:[0,1,1] neg_lo:[1,0,0]
    v_pk_fma_f16 v102, v100, v64, v102 op_sel:[1,1,0] op_sel_hi:[0,1,1] neg_lo:[1,0,0]
    v_pk_mul_f16 v103, v101, v64 op_sel_hi:[1,0]
    v_pk_mul_f16 v104, v100, v65 op_sel_hi:[1,0]
    v_pk_fma_f16 v103, v101, v64, v103 op_sel:[1,1,0] op_sel_hi:[0,1,1] neg_lo:[1,0,0]
    v_pk_fma_f16 v104, v100, v65, v104 op_sel:[1,1,0] op_sel_hi:[0,1,1] neg_lo:[1,0,0]
    v_pk_mul_f16 v105, v101, v65 op_sel_hi:[1,0]
    v_pk_mul_f16 v106, v102, v65 op_sel_hi:[1,0]
    v_pk_fma_f16 v105, v101, v65, v105 op_sel:[1,1,0] op_sel_hi:[0,1,1] neg_lo:[1,0,0]
    v_pk_fma_f16 v106, v102, v65, v106 op_sel:[1,1,0] op_sel_hi:[0,1,1] neg_lo:[1,0,0]
    v_pk_mul_f16 v107, v103, v65 op_sel_hi:[1,0]
    v_pk_mul_f16 v108, v100, v66 op_sel_hi:[1,0]
    v_pk_fma_f16 v107, v103, v65, v107 op_sel:[1,1,0] op_sel_hi:[0,1,1] neg_lo:[1,0,0]
    v_pk_fma_f16 v108, v100, v66, v108 op_sel:[1,1,0] op_sel_hi:[0,1,1] neg_lo:[1,0,0]
    v_pk_mul_f16 v109, v100, v67 op_sel_hi:[1,0]
    v_pk_mul_f16 v110, v108, v67 op_sel_hi:[1,0]
    v_pk_fma_f16 v109, v100, v67, v109 op_sel:[1,1,0] op_sel_hi:[0,1,1] neg_lo:[1,0,0]
    v_pk_fma_f16 v110, v108, v67, v110 op_sel:[1,1,0] op_sel_hi:[0,1,1] neg_lo:[1,0,0]
    s_barrier
    s_cmp_lg_u32 s3, 0
    s_cbranch_scc1 w0_2
    buffer_load_dword v255, off, s[28:31], 0 sc1
w0_2:
    v_pk_mul_f16 v111, v100, v68 op_sel_hi:[1,0]
    v_pk_mul_f16 v112, v108, v68 op_sel_hi:[1,0]
    v_pk_fma_f16 v111, v100, v68, v111 op_sel:[1,1,0] op_sel_hi:[0,1,1] neg_lo:[1,0,0]
    v_pk_fma_f16 v112, v108, v68, v112 op_sel:[1,1,0] op_sel_hi:[0,1,1] neg_lo:[1,0,0]
    v_pk_mul_f16 v113, v109, v68 op_sel_hi:[1,0]
    v_pk_mul_f16 v114, v110, v68 op_sel_hi:[1,0]
    v_pk_fma_f16 v113, v109, v68, v113 op_sel:[1,1,0] op_sel_hi:[0,1,1] neg_lo:[1,0,0]
    v_pk_fma_f16 v114, v110, v68, v114 op_sel:[1,1,0] op_sel_hi:[0,1,1] neg_lo:[1,0,0]
    v_pk_mul_f16 v115, v100, v69 op_sel_hi:[1,0]
    v_pk_mul_f16 v116, v102, v66 op_sel_hi:[1,0]
    v_pk_fma_f16 v115, v100, v69, v115 op_sel:[1,1,0] op_sel_hi:[0,1,1] neg_lo:[1,0,0]
    v_pk_fma_f16 v116, v102, v66, v116 op_sel:[1,1,0] op_sel_hi:[0,1,1] neg_lo:[1,0,0]
    v_pk_mul_f16 v117, v104, v66 op_sel_hi:[1,0]
    v_pk_mul_f16 v118, v106, v66 op_sel_hi:[1,0]
    v_pk_fma_f16 v117, v104, v66, v117 op_sel:[1,1,0] op_sel_hi:[0,1,1] neg_lo:[1,0,0]
    v_pk_fma_f16 v118, v106, v66, v118 op_sel:[1,1,0] op_sel_hi:[0,1,1] neg_lo:[1,0,0]
    v_pk_mul_f16 v119, v104, v67 op_sel_hi:[1,0]
    v_pk_mul_f16 v120, v117, v67 op_sel_hi:[1,0]
    v_pk_fma_f16 v119, v104, v67, v119 op_sel:[1,1,0] op_sel_hi:[0,1,1] neg_lo:[1,0,0]
    v_pk_fma_f16 v120, v117, v67, v120 op_sel:[1,1,0] op_sel_hi:[0,1,1] neg_lo:[1,0,0]
    v_pk_mul_f16 v121, v147, v148 op_sel_hi:[1,0]
    v_pk_mul_f16 v122, v147, v149 op_sel_hi:[1,0]
    s_barrier
    v_pk_fma_f16 v121, v147, v148, v121 op_sel:[1,1,0] op_sel_hi:[0,1,1] neg_lo:[1,0,0]
    v_pk_fma_f16 v122, v147, v149, v122 op_sel:[1,1,0] op_sel_hi:[0,1,1] neg_lo:[1,0,0]
    v_pk_mul_f16 v123, v148, v149 op_sel_hi:[1,0]
    v_pk_mul_f16 v124, v121, v149 op_sel_hi:[1,0]
    v_pk_fma_f16 v123, v148, v149, v123 op_sel:[1,1,0] op_sel_hi:[0,1,1] neg_lo:[1,0,0]
    v_pk_fma_f16 v124, v121, v149, v124 op_sel:[1,1,0] op_sel_hi:[0,1,1] neg_lo:[1,0,0]
    v_pk_mul_f16 v125, v147, v150 op_sel_hi:[1,0]
    v_pk_mul_f16 v126, v148, v150 op_sel_hi:[1,0]
    v_pk_fma_f16 v125, v147, v150, v125 op_sel:[1,1,0] op_sel_hi:[0,1,1] neg_lo:[1,0,0]
    v_pk_fma_f16 v126, v148, v150, v126 op_sel:[1,1,0] op_sel_hi:[0,1,1] neg_lo:[1,0,0]
    v_pk_mul_f16 v127, v121, v150 op_sel_hi:[1,0]
    v_pk_mul_f16 v128, v149, v150 op_sel_hi:[1,0]
    v_pk_fma_f16 v127, v121, v150, v127 op_sel:[1,1,0] op_sel_hi:[0,1,1] neg_lo:[1,0,0]
    v_pk_fma_f16 v128, v149, v150, v128 op_sel:[1,1,0] op_sel_hi:[0,1,1] neg_lo:[1,0,0]
    v_pk_mul_f16 v129, v122, v150 op_sel_hi:[1,0]
    v_pk_mul_f16 v130, v123, v150 op_sel_hi:[1,0]
    v_pk_fma_f16 v129, v122, v150, v129 op_sel:[1,1,0] op_sel_hi:[0,1,1] neg_lo:[1,0,0]
    v_pk_fma_f16 v130, v123, v150, v130 op_sel:[1,1,0] op_sel_hi:[0,1,1] neg_lo:[1,0,0]
    v_pk_mul_f16 v131, v124, v150 op_sel_hi:[1,0]
    v_pk_mul_f16 v132, v147, v151 op_sel_hi:[1,0]
    v_pk_fma_f16 v131, v124, v150, v131 op_sel:[1,1,0] op_sel_hi:[0,1,1] neg_lo:[1,0,0]
    v_pk_fma_f16 v132, v147, v151, v132 op_sel:[1,1,0] op_sel_hi:[0,1,1] neg_lo:[1,0,0]
    s_barrier
    v_pk_mul_f16 v133, v148, v151 op_sel_hi:[1,0]
    v_pk_mul_f16 v134, v121, v151 op_sel_hi:[1,0]
    v_pk_fma_f16 v133, v148, v151, v133 op_sel:[1,1,0] op_sel_hi:[0,1,1] neg_lo:[1,0,0]
    v_pk_fma_f16 v134, v121, v151, v134 op_sel:[1,1,0] op_sel_hi:[0,1,1] neg_lo:[1,0,0]
    v_pk_mul_f16 v135, v149, v151 op_sel_hi:[1,0]
    v_pk_mul_f16 v136, v122, v151 op_sel_hi:[1,0]
    v_pk_fma_f16 v135, v149, v151, v135 op_sel:[1,1,0] op_sel_hi:[0,1,1] neg_lo:[1,0,0]
    v_pk_fma_f16 v136, v122, v151, v136 op_sel:[1,1,0] op_sel_hi:[0,1,1] neg_lo:[1,0,0]
    v_pk_mul_f16 v137, v123, v151 op_sel_hi:[1,0]
    v_pk_mul_f16 v138, v124, v151 op_sel_hi:[1,0]
    v_pk_fma_f16 v137, v123, v151, v137 op_sel:[1,1,0] op_sel_hi:[0,1,1] neg_lo:[1,0,0]
    v_pk_fma_f16 v138, v124, v151, v138 op_sel:[1,1,0] op_sel_hi:[0,1,1] neg_lo:[1,0,0]
    v_pk_mul_f16 v139, v150, v151 op_sel_hi:[1,0]
    v_pk_mul_f16 v140, v125, v151 op_sel_hi:[1,0]
    v_pk_fma_f16 v139, v150, v151, v139 op_sel:[1,1,0] op_sel_hi:[0,1,1] neg_lo:[1,0,0]
    v_pk_fma_f16 v140, v125, v151, v140 op_sel:[1,1,0] op_sel_hi:[0,1,1] neg_lo:[1,0,0]
    v_pk_mul_f16 v141, v126, v151 op_sel_hi:[1,0]
    v_pk_mul_f16 v142, v127, v151 op_sel_hi:[1,0]
    v_pk_fma_f16 v141, v126, v151, v141 op_sel:[1,1,0] op_sel_hi:[0,1,1] neg_lo:[1,0,0]
    v_pk_fma_f16 v142, v127, v151, v142 op_sel:[1,1,0] op_sel_hi:[0,1,1] neg_lo:[1,0,0]
    v_pk_mul_f16 v143, v128, v151 op_sel_hi:[1,0]
    v_pk_mul_f16 v144, v129, v151 op_sel_hi:[1,0]
    s_barrier
    s_cmp_lg_u32 s3, 0
    s_cbranch_scc1 w0_3
    s_mov_b64 exec, 1
    s_mov_b32 s76, 0
    s_branch RDYc_6
RDY_4:
    s_sleep 4
    buffer_load_dword v255, off, s[28:31], 0 sc1
    s_waitcnt vmcnt(0)
RDYc_6:
    s_waitcnt vmcnt(0)
    v_cmp_ne_u32 vcc, 1, v255
    s_add_u32 s76, s76, 1
    s_cmp_gt_u32 s76, 200000
    s_cbranch_scc1 RDYx_5
    s_cbranch_vccnz RDY_4
RDYx_5:
    s_mov_b64 exec, -1
w0_3:
    v_pk_fma_f16 v143, v128, v151, v143 op_sel:[1,1,0] op_sel_hi:[0,1,1] neg_lo:[1,0,0]
    v_pk_fma_f16 v144, v129, v151, v144 op_sel:[1,1,0] op_sel_hi:[0,1,1] neg_lo:[1,0,0]
    v_pk_mul_f16 v145, v130, v151 op_sel_hi:[1,0]
    v_pk_mul_f16 v146, v131, v151 op_sel_hi:[1,0]
    v_pk_fma_f16 v145, v130, v151, v145 op_sel:[1,1,0] op_sel_hi:[0,1,1] neg_lo:[1,0,0]
    v_pk_fma_f16 v146, v131, v151, v146 op_sel:[1,1,0] op_sel_hi:[0,1,1] neg_lo:[1,0,0]
    v_pk_mul_f16 v153, v152, v70 op_sel_hi:[1,0]
    v_pk_mul_f16 v154, v152, v71 op_sel_hi:[1,0]
    v_pk_fma_f16 v153, v152, v70, v153 op_sel:[1,1,0] op_sel_hi:[0,1,1] neg_lo:[1,0,0]
    v_pk_fma_f16 v154, v152, v71, v154 op_sel:[1,1,0] op_sel_hi:[0,1,1] neg_lo:[1,0,0]
    v_pk_mul_f16 v155, v153, v71 op_sel_hi:[1,0]
    v_pk_mul_f16 v156, v152, v72 op_sel_hi:[1,0]
    v_pk_fma_f16 v155, v153, v71, v155 op_sel:[1,1,0] op_sel_hi:[0,1,1] neg_lo:[1,0,0]
    v_pk_fma_f16 v156, v152, v72, v156 op_sel:[1,1,0] op_sel_hi:[0,1,1] neg_lo:[1,0,0]
    v_pk_mul_f16 v157, v153, v72 op_sel_hi:[1,0]
    v_pk_mul_f16 v158, v154, v72 op_sel_hi:[1,0]
    v_pk_fma_f16 v157, v153, v72, v157 op_sel:[1,1,0] op_sel_hi:[0,1,1] neg_lo:[1,0,0]
    v_pk_fma_f16 v158, v154, v72, v158 op_sel:[1,1,0] op_sel_hi:[0,1,1] neg_lo:[1,0,0]
    v_pk_mul_f16 v159, v155, v72 op_sel_hi:[1,0]
    v_pk_mul_f16 v160, v152, v73 op_sel_hi:[1,0]
    v_pk_fma_f16 v159, v155, v72, v159 op_sel:[1,1,0] op_sel_hi:[0,1,1] neg_lo:[1,0,0]
    v_pk_fma_f16 v160, v152, v73, v160 op_sel:[1,1,0] op_sel_hi:[0,1,1] neg_lo:[1,0,0]
    s_barrier
    v_pk_mul_f16 v161, v152, v74 op_sel_hi:[1,0]
    v_pk_mul_f16 v162, v160, v74 op_sel_hi:[1,0]
    v_pk_fma_f16 v161, v152, v74, v161 op_sel:[1,1,0] op_sel_hi:[0,1,1] neg_lo:[1,0,0]
    v_pk_fma_f16 v162, v160, v74, v162 op_sel:[1,1,0] op_sel_hi:[0,1,1] neg_lo:[1,0,0]
    v_pk_mul_f16 v163, v152, v75 op_sel_hi:[1,0]
    v_pk_mul_f16 v164, v160, v75 op_sel_hi:[1,0]
    v_pk_fma_f16 v163, v152, v75, v163 op_sel:[1,1,0] op_sel_hi:[0,1,1] neg_lo:[1,0,0]
    v_pk_fma_f16 v164, v160, v75, v164 op_sel:[1,1,0] op_sel_hi:[0,1,1] neg_lo:[1,0,0]
    v_pk_mul_f16 v165, v161, v75 op_sel_hi:[1,0]
    v_pk_mul_f16 v166, v162, v75 op_sel_hi:[1,0]
    v_pk_fma_f16 v165, v161, v75, v165 op_sel:[1,1,0] op_sel_hi:[0,1,1] neg_lo:[1,0,0]
    v_pk_fma_f16 v166, v162, v75, v166 op_sel:[1,1,0] op_sel_hi:[0,1,1] neg_lo:[1,0,0]
    v_pk_mul_f16 v167, v152, v76 op_sel_hi:[1,0]
    v_pk_mul_f16 v168, v154, v73 op_sel_hi:[1,0]
    v_pk_fma_f16 v167, v152, v76, v167 op_sel:[1,1,0] op_sel_hi:[0,1,1] neg_lo:[1,0,0]
    v_pk_fma_f16 v168, v154, v73, v168 op_sel:[1,1,0] op_sel_hi:[0,1,1] neg_lo:[1,0,0]
    v_pk_mul_f16 v169, v156, v73 op_sel_hi:[1,0]
    v_pk_mul_f16 v170, v158, v73 op_sel_hi:[1,0]
    v_pk_fma_f16 v169, v156, v73, v169 op_sel:[1,1,0] op_sel_hi:[0,1,1] neg_lo:[1,0,0]
    v_pk_fma_f16 v170, v158, v73, v170 op_sel:[1,1,0] op_sel_hi:[0,1,1] neg_lo:[1,0,0]
    v_pk_mul_f16 v171, v156, v74 op_sel_hi:[1,0]
    v_pk_mul_f16 v172, v169, v74 op_sel_hi:[1,0]
    s_barrier
    v_pk_fma_f16 v171, v156, v74, v171 op_sel:[1,1,0] op_sel_hi:[0,1,1] neg_lo:[1,0,0]
    v_pk_fma_f16 v172, v169, v74, v172 op_sel:[1,1,0] op_sel_hi:[0,1,1] neg_lo:[1,0,0]
    v_pk_mul_f16 v173, v199, v200 op_sel_hi:[1,0]
    v_pk_mul_f16 v174, v199, v201 op_sel_hi:[1,0]
    v_pk_fma_f16 v173, v199, v200, v173 op_sel:[1,1,0] op_sel_hi:[0,1,1] neg_lo:[1,0,0]
    v_pk_fma_f16 v174, v199, v201, v174 op_sel:[1,1,0] op_sel_hi:[0,1,1] neg_lo:[1,0,0]
    v_pk_mul_f16 v175, v200, v201 op_sel_hi:[1,0]
    v_pk_mul_f16 v176, v173, v201 op_sel_hi:[1,0]
    v_pk_fma_f16 v175, v200, v201, v175 op_sel:[1,1,0] op_sel_hi:[0,1,1] neg_lo:[1,0,0]
    v_pk_fma_f16 v176, v173, v201, v176 op_sel:[1,1,0] op_sel_hi:[0,1,1] neg_lo:[1,0,0]
    v_pk_mul_f16 v177, v199, v202 op_sel_hi:[1,0]
    v_pk_mul_f16 v178, v200, v202 op_sel_hi:[1,0]
    v_pk_fma_f16 v177, v199, v202, v177 op_sel:[1,1,0] op_sel_hi:[0,1,1] neg_lo:[1,0,0]
    v_pk_fma_f16 v178, v200, v202, v178 op_sel:[1,1,0] op_sel_hi:[0,1,1] neg_lo:[1,0,0]
    v_pk_mul_f16 v179, v173, v202 op_sel_hi:[1,0]
    v_pk_mul_f16 v180, v201, v202 op_sel_hi:[1,0]
    v_pk_fma_f16 v179, v173, v202, v179 op_sel:[1,1,0] op_sel_hi:[0,1,1] neg_lo:[1,0,0]
    v_pk_fma_f16 v180, v201, v202, v180 op_sel:[1,1,0] op_sel_hi:[0,1,1] neg_lo:[1,0,0]
    v_pk_mul_f16 v181, v174, v202 op_sel_hi:[1,0]
    v_pk_mul_f16 v182, v175, v202 op_sel_hi:[1,0]
    v_pk_fma_f16 v181, v174, v202, v181 op_sel:[1,1,0] op_sel_hi:[0,1,1] neg_lo:[1,0,0]
    v_pk_fma_f16 v182, v175, v202, v182 op_sel:[1,1,0] op_sel_hi:[0,1,1] neg_lo:[1,0,0]
    s_barrier
    v_pk_mul_f16 v183, v176, v202 op_sel_hi:[1,0]
    v_pk_mul_f16 v184, v199, v203 op_sel_hi:[1,0]
    v_pk_fma_f16 v183, v176, v202, v183 op_sel:[1,1,0] op_sel_hi:[0,1,1] neg_lo:[1,0,0]
    v_pk_fma_f16 v184, v199, v203, v184 op_sel:[1,1,0] op_sel_hi:[0,1,1] neg_lo:[1,0,0]
    v_pk_mul_f16 v185, v200, v203 op_sel_hi:[1,0]
    v_pk_mul_f16 v186, v173, v203 op_sel_hi:[1,0]
    v_pk_fma_f16 v185, v200, v203, v185 op_sel:[1,1,0] op_sel_hi:[0,1,1] neg_lo:[1,0,0]
    v_pk_fma_f16 v186, v173, v203, v186 op_sel:[1,1,0] op_sel_hi:[0,1,1] neg_lo:[1,0,0]
    v_pk_mul_f16 v187, v201, v203 op_sel_hi:[1,0]
    v_pk_mul_f16 v188, v174, v203 op_sel_hi:[1,0]
    v_pk_fma_f16 v187, v201, v203, v187 op_sel:[1,1,0] op_sel_hi:[0,1,1] neg_lo:[1,0,0]
    v_pk_fma_f16 v188, v174, v203, v188 op_sel:[1,1,0] op_sel_hi:[0,1,1] neg_lo:[1,0,0]
    v_pk_mul_f16 v189, v175, v203 op_sel_hi:[1,0]
    v_pk_mul_f16 v190, v176, v203 op_sel_hi:[1,0]
    v_pk_fma_f16 v189, v175, v203, v189 op_sel:[1,1,0] op_sel_hi:[0,1,1] neg_lo:[1,0,0]
    v_pk_fma_f16 v190, v176, v203, v190 op_sel:[1,1,0] op_sel_hi:[0,1,1] neg_lo:[1,0,0]
    v_pk_mul_f16 v191, v202, v203 op_sel_hi:[1,0]
    v_pk_mul_f16 v192, v177, v203 op_sel_hi:[1,0]
    v_pk_fma_f16 v191, v202, v203, v191 op_sel:[1,1,0] op_sel_hi:[0,1,1] neg_lo:[1,0,0]
    v_pk_fma_f16 v192, v177, v203, v192 op_sel:[1,1,0] op_sel_hi:[0,1,1] neg_lo:[1,0,0]
    v_pk_mul_f16 v193, v178, v203 op_sel_hi:[1,0]
    v_pk_mul_f16 v194, v179, v203 op_sel_hi:[1,0]
    s_barrier
    v_pk_fma_f16 v193, v178, v203, v193 op_sel:[1,1,0] op_sel_hi:[0,1,1] neg_lo:[1,0,0]
    v_pk_fma_f16 v194, v179, v203, v194 op_sel:[1,1,0] op_sel_hi:[0,1,1] neg_lo:[1,0,0]
    v_pk_mul_f16 v195, v180, v203 op_sel_hi:[1,0]
    v_pk_mul_f16 v196, v181, v203 op_sel_hi:[1,0]
    v_pk_fma_f16 v195, v180, v203, v195 op_sel:[1,1,0] op_sel_hi:[0,1,1] neg_lo:[1,0,0]
    v_pk_fma_f16 v196, v181, v203, v196 op_sel:[1,1,0] op_sel_hi:[0,1,1] neg_lo:[1,0,0]
    v_pk_mul_f16 v197, v182, v203 op_sel_hi:[1,0]
    v_pk_mul_f16 v198, v183, v203 op_sel_hi:[1,0]
    v_pk_fma_f16 v197, v182, v203, v197 op_sel:[1,1,0] op_sel_hi:[0,1,1] neg_lo:[1,0,0]
    v_pk_fma_f16 v198, v183, v203, v198 op_sel:[1,1,0] op_sel_hi:[0,1,1] neg_lo:[1,0,0]
    v_lshrrev_b32 v207, 6, v254
    v_and_b32 v204, 0x10001, v254
    v_and_b32 v205, 0x10001, v205
    v_and_b32 v206, 0x10001, v206
    v_and_b32 v207, 0x10001, v207
    v_mul_u32_u24 v204, 0x3f80, v204
    v_mul_u32_u24 v205, 0x3f80, v205
    v_mul_u32_u24 v206, 0x3f80, v206
    v_mul_u32_u24 v207, 0x3f80, v207
    s_mov_b32 s62, 0x1c0000
    v_lshrrev_b32_e64 v254, v237, s62
    v_and_b32 v254, 0xff, v254
    v_lshl_or_b32 v254, v254, 15, v254
    s_barrier
    v_lshrrev_b32 v209, 2, v254
    v_lshrrev_b32 v210, 4, v254
    v_lshrrev_b32 v211, 6, v254
    v_and_b32 v208, 0x10001, v254
    v_and_b32 v209, 0x10001, v209
    v_and_b32 v210, 0x10001, v210
    v_and_b32 v211, 0x10001, v211
    v_mul_u32_u24 v208, 0x3f80, v208
    v_mul_u32_u24 v209, 0x3f80, v209
    v_mul_u32_u24 v210, 0x3f80, v210
    v_mul_u32_u24 v211, 0x3f80, v211
    s_mov_b32 s62, 0x1c000000
    v_lshrrev_b32_e64 v254, v237, s62
    v_and_b32 v254, 0xff, v254
    v_lshl_or_b32 v254, v254, 15, v254
    v_lshrrev_b32 v213, 2, v254
    v_lshrrev_b32 v214, 4, v254
    v_lshrrev_b32 v215, 6, v254
    v_and_b32 v212, 0x10001, v254
    v_and_b32 v213, 0x10001, v213
    v_and_b32 v214, 0x10001, v214
    v_and_b32 v215, 0x10001, v215
    v_mul_u32_u24 v212, 0x3f80, v212
    s_barrier
    v_mul_u32_u24 v213, 0x3f80, v213
    v_mul_u32_u24 v214, 0x3f80, v214
    v_mul_u32_u24 v215, 0x3f80, v215
    s_mov_b32 s62, 0xff80000
    v_lshrrev_b32_e64 v254, v237, s62
    v_and_b32 v254, 0xff, v254
    v_lshl_or_b32 v254, v254, 15, v254
    v_lshrrev_b32 v217, 2, v254
    v_lshrrev_b32 v218, 4, v254
    v_lshrrev_b32 v219, 6, v254
    v_and_b32 v216, 0x10001, v254
    v_and_b32 v217, 0x10001, v217
    v_and_b32 v218, 0x10001, v218
    v_and_b32 v219, 0x10001, v219
    v_mul_u32_u24 v216, 0x3f80, v216
    v_mul_u32_u24 v217, 0x3f80, v217
    v_mul_u32_u24 v218, 0x3f80, v218
    v_mul_u32_u24 v219, 0x3f80, v219
    s_mov_b32 s62, 0x7f00000
    v_lshrrev_b32_e64 v254, v237, s62
    v_and_b32 v254, 0xff, v254
    v_lshl_or_b32 v254, v254, 15, v254
    v_lshrrev_b32 v221, 2, v254
    v_lshrrev_b32 v222, 4, v254
    s_barrier
    v_lshrrev_b32 v223, 6, v254
    v_and_b32 v220, 0x10001, v254
    v_and_b32 v221, 0x10001, v221
    v_and_b32 v222, 0x10001, v222
    v_and_b32 v223, 0x10001, v223
    v_mul_u32_u24 v220, 0x3f80, v220
    v_mul_u32_u24 v221, 0x3f80, v221
    v_mul_u32_u24 v222, 0x3f80, v222
    v_mul_u32_u24 v223, 0x3f80, v223
    s_mov_b32 s62, 0x18000000
    v_lshrrev_b32_e64 v254, v237, s62
    v_and_b32 v254, 0xff, v254
    v_lshl_or_b32 v254, v254, 15, v254
    v_mov_b32 v237, v254
    s_barrier
    s_cmp_lg_u32 s3, 0
    s_cbranch_scc1 w0_7
    s_movk_i32 s75, 2048
    s_mov_b64 exec, 3
    buffer_load_dword v255, v2, s[12:15], s75 offen sc1
    s_mov_b64 exec, -1
w0_7:
    s_mov_b32 m0, s57
    v_mov_b32 v252, 0x3c00
    ds_write_addtid_b32 v252 offset:34688
    ds_write_addtid_b32 v4 offset:43392
    ds_write_addtid_b32 v51 offset:34960
    ds_write_addtid_b32 v52 offset:35232
    ds_write_addtid_b32 v53 offset:35776
    ds_write_addtid_b32 v54 offset:36864
    ds_write_addtid_b32 v55 offset:39040
    ds_write_addtid_b32 v5 offset:43664
    ds_write_addtid_b32 v6 offset:43936
    ds_write_addtid_b32 v7 offset:44208
    ds_write_addtid_b32 v8 offset:45568
    ds_write_addtid_b32 v9 offset:45840
    ds_write_addtid_b32 v10 offset:46112
    ds_write_addtid_b32 v11 offset:46384
    ds_write_addtid_b32 v12 offset:44480
    s_barrier
    ds_write_addtid_b32 v13 offset:47744
    ds_write_addtid_b32 v14 offset:48832
    ds_write_addtid_b32 v15 offset:48288
    ds_write_addtid_b32 v16 offset:49376
    ds_write_addtid_b32 v17 offset:48560
    ds_write_addtid_b32 v18 offset:49648
    ds_write_addtid_b32 v19 offset:46928
    ds_write_addtid_b32 v20 offset:45024
    ds_write_addtid_b32 v21 offset:46656
    ds_write_addtid_b32 v22 offset:47200
    ds_write_addtid_b32 v23 offset:48016
    ds_write_addtid_b32 v24 offset:49104
    ds_write_addtid_b32 v25 offset:35504
    ds_write_addtid_b32 v26 offset:36048
    ds_write_addtid_b32 v27 offset:36320
    s_cmp_lg_u32 s3, 0
    s_cbranch_scc1 w0_8
    s_mov_b64 exec, 3
    s_mov_b32 s76, 0
    s_branch PREc_11
PRE_9:
    s_sleep 4
    buffer_load_dword v255, v2, s[12:15], s75 offen sc1
    s_waitcnt vmcnt(0)
PREc_11:
    s_waitcnt vmcnt(0)
    v_cmp_ne_u32 vcc, 0x01010101, v255
    s_add_u32 s76, s76, 1
    s_cmp_gt_u32 s76, 200000
    s_cbranch_scc1 PREx_10
    s_cbranch_vccnz PRE_9
PREx_10:
    s_mov_b64 exec, -1
w0_8:
    s_barrier
    ds_write_addtid_b32 v28 offset:36592
    ds_write_addtid_b32 v29 offset:37136
    ds_write_addtid_b32 v30 offset:37408
    ds_write_addtid_b32 v31 offset:37680
    ds_write_addtid_b32 v32 offset:37952
    ds_write_addtid_b32 v33 offset:38224
    ds_write_addtid_b32 v34 offset:38496
    ds_write_addtid_b32 v35 offset:38768
    ds_write_addtid_b32 v36 offset:39312
    ds_write_addtid_b32 v37 offset:39584
    ds_write_addtid_b32 v38 offset:39856
    ds_write_addtid_b32 v39 offset:40128
    ds_write_addtid_b32 v40 offset:40400
    ds_write_addtid_b32 v41 offset:40672
    ds_write_addtid_b32 v42 offset:40944
    s_barrier
    s_setprio 3
    ds_write_addtid_b32 v43 offset:41216
    ds_write_addtid_b32 v44 offset:41488
    ds_write_addtid_b32 v45 offset:41760
    ds_write_addtid_b32 v46 offset:42032
    ds_write_addtid_b32 v47 offset:42304
    ds_write_addtid_b32 v48 offset:42576
    ds_write_addtid_b32 v49 offset:42848
    ds_write_addtid_b32 v50 offset:43120
    buffer_load_dwordx4 v[4:7], v241, s[12:15], s66 offen offset:0 sc1
    buffer_load_dwordx4 v[8:11], v241, s[12:15], s66 offen offset:2048 sc1
    buffer_load_dwordx4 v[12:15], v241, s[12:15], s67 offen offset:0 sc1
    buffer_load_dwordx4 v[16:19], v241, s[12:15], s67 offen offset:2048 sc1
    ds_read_b128 v[20:23], v224 offset:43392
    ds_read_b128 v[24:27], v224 offset:43424
    ds_read_b128 v[28:31], v224 offset:43456
    ds_read_b128 v[32:35], v224 offset:43488
    ds_read_b128 v[36:39], v224 offset:43520
    ds_read_b128 v[40:43], v224 offset:43552
    ds_read_b128 v[44:47], v224 offset:43584
    ds_read_b128 v[48:51], v224 offset:43616
    ds_read_b128 v[52:55], v225 offset:34688
    ds_write_addtid_b32 v100 offset:43392
    ds_write_addtid_b32 v101 offset:43664
    ds_read_b128 v[56:59], v225 offset:34720
    ds_write_addtid_b32 v102 offset:43936
    ds_write_addtid_b32 v103 offset:44208
    ds_read_b128 v[60:63], v225 offset:34752
    ds_write_addtid_b32 v104 offset:45568
    ds_write_addtid_b32 v105 offset:45840
    ds_read_b128 v[64:67], v225 offset:34784
    ds_write_addtid_b32 v106 offset:46112
    ds_write_addtid_b32 v107 offset:46384
    ds_read_b128 v[68:71], v225 offset:34816
    ds_write_addtid_b32 v108 offset:44480
    ds_write_addtid_b32 v109 offset:47744
    ds_read_b128 v[72:75], v225 offset:34848
    ds_write_addtid_b32 v110 offset:48832
    ds_write_addtid_b32 v111 offset:48288
    ds_read_b128 v[76:79], v225 offset:34880
    ds_write_addtid_b32 v112 offset:49376
    ds_write_addtid_b32 v113 offset:48560
    ds_read_b128 v[80:83], v225 offset:34912
    ds_write_addtid_b32 v114 offset:49648
    ds_write_addtid_b32 v115 offset:46928
    ds_write_addtid_b32 v116 offset:45024
    ds_write_addtid_b32 v117 offset:46656
    ds_write_addtid_b32 v118 offset:47200
    ds_write_addtid_b32 v119 offset:48016
    ds_write_addtid_b32 v120 offset:49104
    ds_read_b128 v[84:87], v224 offset:43392
    ds_write_addtid_b32 v147 offset:34960
    ds_write_addtid_b32 v148 offset:35232
    ds_write_addtid_b32 v149 offset:35776
    ds_read_b128 v[88:91], v224 offset:43424
    ds_write_addtid_b32 v150 offset:36864
    ds_write_addtid_b32 v151 offset:39040
    ds_write_addtid_b32 v121 offset:35504
    ds_read_b128 v[92:95], v224 offset:43456
    ds_write_addtid_b32 v122 offset:36048
    ds_write_addtid_b32 v123 offset:36320
    ds_write_addtid_b32 v124 offset:36592
    ds_read_b128 v[96:99], v224 offset:43488
    ds_write_addtid_b32 v125 offset:37136
    ds_write_addtid_b32 v126 offset:37408
    ds_write_addtid_b32 v127 offset:37680
    ds_read_b128 v[100:103], v224 offset:43520
    ds_write_addtid_b32 v128 offset:37952
    ds_write_addtid_b32 v129 offset:38224
    ds_write_addtid_b32 v130 offset:38496
    ds_read_b128 v[104:107], v224 offset:43552
    ds_write_addtid_b32 v131 offset:38768
    ds_write_addtid_b32 v132 offset:39312
    ds_write_addtid_b32 v133 offset:39584
    ds_read_b128 v[108:111], v224 offset:43584
    ds_write_addtid_b32 v134 offset:39856
    ds_write_addtid_b32 v135 offset:40128
    ds_write_addtid_b32 v136 offset:40400
    ds_read_b128 v[112:115], v224 offset:43616
    ds_write_addtid_b32 v137 offset:40672
    ds_write_addtid_b32 v138 offset:40944
    ds_write_addtid_b32 v139 offset:41216
    ds_write_addtid_b32 v140 offset:41488
    ds_write_addtid_b32 v141 offset:41760
    ds_write_addtid_b32 v142 offset:42032
    ds_write_addtid_b32 v143 offset:42304
    ds_write_addtid_b32 v144 offset:42576
    ds_write_addtid_b32 v145 offset:42848
    ds_write_addtid_b32 v146 offset:43120
    ds_read_b128 v[116:119], v225 offset:34688
    ds_write_addtid_b32 v152 offset:43392
    ds_write_addtid_b32 v153 offset:43664
    ds_read_b128 v[120:123], v225 offset:34720
    ds_write_addtid_b32 v154 offset:43936
    ds_write_addtid_b32 v155 offset:44208
    ds_read_b128 v[124:127], v225 offset:34752
    ds_write_addtid_b32 v156 offset:45568
    ds_write_addtid_b32 v157 offset:45840
    ds_read_b128 v[128:131], v225 offset:34784
    ds_write_addtid_b32 v158 offset:46112
    ds_write_addtid_b32 v159 offset:46384
    ds_read_b128 v[132:135], v225 offset:34816
    ds_write_addtid_b32 v160 offset:44480
    ds_write_addtid_b32 v161 offset:47744
    ds_read_b128 v[136:139], v225 offset:34848
    ds_write_addtid_b32 v162 offset:48832
    ds_write_addtid_b32 v163 offset:48288
    ds_read_b128 v[140:143], v225 offset:34880
    ds_write_addtid_b32 v164 offset:49376
    ds_write_addtid_b32 v165 offset:48560
    ds_read_b128 v[144:147], v225 offset:34912
    ds_write_addtid_b32 v166 offset:49648
    ds_write_addtid_b32 v167 offset:46928
    ds_write_addtid_b32 v168 offset:45024
    ds_write_addtid_b32 v169 offset:46656
    ds_write_addtid_b32 v170 offset:47200
    ds_write_addtid_b32 v171 offset:48016
    ds_write_addtid_b32 v172 offset:49104
    ds_read_b128 v[148:151], v224 offset:43392
    ds_write_addtid_b32 v199 offset:34960
    ds_write_addtid_b32 v200 offset:35232
    ds_write_addtid_b32 v201 offset:35776
    ds_write_addtid_b32 v202 offset:36864
    ds_read_b128 v[152:155], v224 offset:43424
    ds_write_addtid_b32 v203 offset:39040
    ds_write_addtid_b32 v173 offset:35504
    ds_write_addtid_b32 v174 offset:36048
    ds_write_addtid_b32 v175 offset:36320
    ds_read_b128 v[156:159], v224 offset:43456
    ds_write_addtid_b32 v176 offset:36592
    ds_write_addtid_b32 v177 offset:37136
    ds_write_addtid_b32 v178 offset:37408
    ds_write_addtid_b32 v179 offset:37680
    ds_read_b128 v[160:163], v224 offset:43488
    ds_write_addtid_b32 v180 offset:37952
    ds_write_addtid_b32 v181 offset:38224
    ds_write_addtid_b32 v182 offset:38496
    ds_write_addtid_b32 v183 offset:38768
    ds_read_b128 v[164:167], v224 offset:43520
    ds_write_addtid_b32 v184 offset:39312
    ds_write_addtid_b32 v185 offset:39584
    ds_write_addtid_b32 v186 offset:39856
    ds_write_addtid_b32 v187 offset:40128
    ds_read_b128 v[168:171], v224 offset:43552
    ds_write_addtid_b32 v188 offset:40400
    ds_write_addtid_b32 v189 offset:40672
    ds_write_addtid_b32 v190 offset:40944
    ds_write_addtid_b32 v191 offset:41216
    ds_read_b128 v[228:231], v224 offset:43584
    ds_write_addtid_b32 v192 offset:41488
    ds_write_addtid_b32 v193 offset:41760
    ds_write_addtid_b32 v194 offset:42032
    ds_write_addtid_b32 v195 offset:42304
    ds_write_addtid_b32 v196 offset:42576
    ds_write_addtid_b32 v197 offset:42848
    ds_write_addtid_b32 v198 offset:43120
    ds_read_b128 v[172:175], v225 offset:34688
    ds_read_b128 v[176:179], v225 offset:34720
    ds_read_b128 v[180:183], v225 offset:34752
    ds_read_b128 v[184:187], v225 offset:34784
    ds_read_b128 v[188:191], v225 offset:34816
    ds_read_b128 v[192:195], v225 offset:34848
    ds_read_b128 v[196:199], v225 offset:34880
    s_waitcnt vmcnt(3)
    ds_write_b128 v242, v[4:7] offset:0
    s_waitcnt vmcnt(2)
    ds_write_b128 v242, v[8:11] offset:256
    s_waitcnt vmcnt(1)
    ds_write_b128 v242, v[12:15] offset:512
    s_waitcnt vmcnt(0)
    ds_write_b128 v242, v[16:19] offset:768
    s_mov_b64 exec, 1
    ds_add_u32 v227, v245 offset:32
    s_mov_b64 exec, -1
    s_mov_b32 s76, 0
    s_branch lw_12f
lw_12:
    s_sleep 1
    s_add_u32 s76, s76, 1
    s_cmp_gt_u32 s76, 1600000
    s_cbranch_scc1 lx_13
lw_12f:
    ds_read_b32 v253, v227 offset:32
    s_waitcnt lgkmcnt(0)
    v_readfirstlane_b32 s60, v253
    s_cmp_lt_u32 s60, 8
    s_cbranch_scc1 lw_12
lx_13:
    v_mfma_f32_32x32x16_f16 v[4:19], v[20:23], v[52:55], 0
    v_mfma_f32_32x32x16_f16 v[4:19], v[24:27], v[56:59], v[4:19]
    ds_read_b128 v[20:23], v224 offset:43616
    ds_read_b128 v[24:27], v225 offset:34912
    v_mfma_f32_32x32x16_f16 v[4:19], v[28:31], v[60:63], v[4:19]
    v_mfma_f32_32x32x16_f16 v[4:19], v[32:35], v[64:67], v[4:19]
    v_mfma_f32_32x32x16_f16 v[4:19], v[36:39], v[68:71], v[4:19]
    v_mfma_f32_32x32x16_f16 v[4:19], v[40:43], v[72:75], v[4:19]
    v_mfma_f32_32x32x16_f16 v[4:19], v[44:47], v[76:79], v[4:19]
    v_mfma_f32_32x32x16_f16 v[4:19], v[48:51], v[80:83], v[4:19]
    v_mfma_f32_32x32x16_f16 v[4:19], v[84:87], v[116:119], v[4:19]
    ds_read_b128 v[68:71], v234 offset:432
    v_lshrrev_b32 v77, 2, v237
    v_mfma_f32_32x32x16_f16 v[4:19], v[88:91], v[120:123], v[4:19]
    ds_read_b128 v[72:75], v234 offset:944
    v_lshrrev_b32 v78, 4, v237
    v_mfma_f32_32x32x16_f16 v[4:19], v[92:95], v[124:127], v[4:19]
    ds_read_b128 v[36:39], v234 offset:448
    v_lshrrev_b32 v79, 6, v237
    v_mfma_f32_32x32x16_f16 v[4:19], v[96:99], v[128:131], v[4:19]
    ds_read_b128 v[40:43], v234 offset:960
    v_and_b32 v76, 0x10001, v237
    v_mfma_f32_32x32x16_f16 v[4:19], v[100:103], v[132:135], v[4:19]
    ds_read_b128 v[44:47], v234 offset:1472
    v_and_b32 v77, 0x10001, v77
    v_mfma_f32_32x32x16_f16 v[4:19], v[104:107], v[136:139], v[4:19]
    ds_read_b128 v[48:51], v234 offset:1984
    v_and_b32 v78, 0x10001, v78
    v_mfma_f32_32x32x16_f16 v[4:19], v[108:111], v[140:143], v[4:19]
    ds_read_b128 v[52:55], v234 offset:2496
    v_and_b32 v79, 0x10001, v79
    v_mfma_f32_32x32x16_f16 v[4:19], v[112:115], v[144:147], v[4:19]
    ds_read_b128 v[56:59], v234 offset:3008
    v_mfma_f32_32x32x16_f16 v[4:19], v[148:151], v[172:175], v[4:19]
    ds_read_b128 v[60:63], v234 offset:3520
    v_mfma_f32_32x32x16_f16 v[4:19], v[152:155], v[176:179], v[4:19]
    ds_read_b128 v[64:67], v234 offset:4032
    v_mfma_f32_32x32x16_f16 v[4:19], v[156:159], v[180:183], v[4:19]
    v_mfma_f32_32x32x16_f16 v[4:19], v[160:163], v[184:187], v[4:19]
    v_mfma_f32_32x32x16_f16 v[4:19], v[164:167], v[188:191], v[4:19]
    v_mfma_f32_32x32x16_f16 v[4:19], v[168:171], v[192:195], v[4:19]
    v_mfma_f32_32x32x16_f16 v[4:19], v[228:231], v[196:199], v[4:19]
    s_waitcnt lgkmcnt(10)
    v_mfma_f32_32x32x16_f16 v[4:19], v[20:23], v[24:27], v[4:19]
    s_waitcnt lgkmcnt(9)
    v_mfma_f32_16x16x32_bf16 v[92:95], v[68:71], v[204:207], 0
    s_waitcnt lgkmcnt(7)
    v_mfma_f32_16x16x32_bf16 v[96:99], v[36:39], v[208:211], 0
    v_mfma_f32_16x16x32_bf16 v[100:103], v[36:39], v[204:207], 0
    v_mfma_f32_16x16x32_bf16 v[104:107], v[36:39], v[212:215], 0
    v_mfma_f32_16x16x32_bf16 v[108:111], v[68:71], v[216:219], 0
    v_mfma_f32_16x16x32_bf16 v[112:115], v[36:39], v[220:223], 0
    ds_read_b128 v[68:71], v234 offset:1456
    v_mfma_f32_16x16x32_bf16 v[116:119], v[72:75], v[204:207], 0
    s_nop 1
    v_mul_f32 v4, v4, v226
    v_mul_f32 v12, v12, v226
    v_mul_f32 v14, v14, v226
    v_mul_f32 v15, v15, v226
    v_mul_f32 v16, v16, v226
    v_mul_f32 v13, v13, v226
    v_mul_f32 v5, v5, v226
    v_mul_f32 v6, v6, v226
    s_waitcnt lgkmcnt(7)
    v_mfma_f32_16x16x32_bf16 v[120:123], v[40:43], v[208:211], 0
    v_mul_f32 v7, v7, v226
    v_mul_f32 v8, v8, v226
    v_mul_f32 v9, v9, v226
    v_mul_f32 v10, v10, v226
    v_mul_f32 v11, v11, v226
    v_mov_b32_dpp v228, v12 wave_rol:1 row_mask:0xf bank_mask:0xf
    v_mov_b32_dpp v229, v14 wave_rol:1 row_mask:0xf bank_mask:0xf
    v_mov_b32_dpp v230, v15 wave_rol:1 row_mask:0xf bank_mask:0xf
    v_mfma_f32_16x16x32_bf16 v[124:127], v[40:43], v[204:207], 0
    v_mov_b32_dpp v231, v16 wave_rol:1 row_mask:0xf bank_mask:0xf
    v_mov_b32_dpp v228, v4 wave_shl:1 row_mask:0xf bank_mask:0xf
    v_mov_b32_dpp v229, v12 wave_shl:1 row_mask:0xf bank_mask:0xf
    v_mov_b32_dpp v230, v14 wave_shl:1 row_mask:0xf bank_mask:0xf
    v_mov_b32_dpp v231, v15 wave_shl:1 row_mask:0xf bank_mask:0xf
    s_mov_b64 exec, 1
    v_add_f32 v4, v4, v238
    s_mov_b32 exec_lo, 0
    s_mov_b32 exec_hi, -1
    v_mov_b32 v11, v228
    s_mov_b32 exec_lo, -1
    v_cvt_pk_bf16_f32 v252, v14, 0
    v_cvt_pk_bf16_f32 v30, v4, 0
    v_mfma_f32_16x16x32_bf16 v[128:131], v[40:43], v[212:215], 0
    v_cvt_pk_bf16_f32 v20, v11, v10
    v_cvt_pk_bf16_f32 v21, v9, v8
    v_cvt_pk_bf16_f32 v22, v7, v6
    v_cvt_pk_bf16_f32 v23, v5, v4
    ds_write_b128 v239, v[20:23] offset:64
    v_cvt_pk_bf16_f32 v24, v228, v11
    v_cvt_pk_bf16_f32 v25, v10, v9
    v_cvt_pk_bf16_f32 v26, v8, v7
    v_mfma_f32_16x16x32_bf16 v[132:135], v[72:75], v[216:219], 0
    v_cvt_pk_bf16_f32 v27, v6, v5
    ds_write_b128 v239, v[24:27] offset:1280
    v_cvt_pk_bf16_f32 v28, 0, v12
    v_cvt_pk_bf16_f32 v29, v12, v12
    v_cvt_pk_bf16_f32 v31, v229, v13
    v_cvt_pk_bf16_f32 v32, v230, v14
    v_cvt_pk_bf16_f32 v33, v231, v15
    v_readfirstlane_b32 s63, v252
    v_mfma_f32_16x16x32_bf16 v[136:139], v[40:43], v[220:223], 0
    s_mov_b64 exec, 1
    ds_write_b32 v240, v30 offset:2304
    ds_write_b64 v240, v[28:29] offset:56
    ds_write_b32 v240, v29 offset:1276
    s_mov_b64 exec, -1
    ds_write_b32 v243, v31 offset:2816
    s_mov_b32 exec_lo, 0xaaaaaaaa
    s_mov_b32 exec_hi, 0xaaaaaaaa
    ds_write_b32 v244, v32 offset:2496
    ds_write_b32 v244, v33 offset:2368
    s_mov_b64 exec, -1
    s_mov_b64 exec, 1
    ds_add_u32 v227, v245 offset:12
    s_mov_b64 exec, -1
    ds_read2_b32 v[80:81], v233 offset0:128 offset1:129
    ds_read2_b32 v[82:83], v233 offset0:130 offset1:131
    ds_read_b128 v[72:75], v234 offset:1968
    v_cvt_pk_bf16_f32 v140, v92, v96
    v_cvt_pk_bf16_f32 v142, v93, v97
    v_cvt_pk_bf16_f32 v144, v94, v98
    v_cvt_pk_bf16_f32 v146, v95, v99
    v_cvt_pk_bf16_f32 v141, v100, v104
    v_cvt_pk_bf16_f32 v143, v101, v105
    v_cvt_pk_bf16_f32 v145, v102, v106
    v_cvt_pk_bf16_f32 v147, v103, v107
    v_cvt_pk_bf16_f32 v148, v108, v112
    v_cvt_pk_bf16_f32 v149, v109, v113
    v_cvt_pk_bf16_f32 v150, v110, v114
    v_cvt_pk_bf16_f32 v151, v111, v115
    s_waitcnt lgkmcnt(12)
    v_mfma_f32_16x16x32_bf16 v[92:95], v[68:71], v[204:207], 0
    v_cvt_pk_bf16_f32 v152, v116, v120
    v_cvt_pk_bf16_f32 v154, v117, v121
    v_mfma_f32_16x16x32_bf16 v[96:99], v[44:47], v[208:211], 0
    v_cvt_pk_bf16_f32 v156, v118, v122
    v_cvt_pk_bf16_f32 v158, v119, v123
    v_mfma_f32_16x16x32_bf16 v[100:103], v[44:47], v[204:207], 0
    v_cvt_pk_bf16_f32 v153, v124, v128
    v_cvt_pk_bf16_f32 v155, v125, v129
    v_mfma_f32_16x16x32_bf16 v[104:107], v[44:47], v[212:215], 0
    v_cvt_pk_bf16_f32 v157, v126, v130
    v_cvt_pk_bf16_f32 v159, v127, v131
    v_mfma_f32_16x16x32_bf16 v[108:111], v[68:71], v[216:219], 0
    v_cvt_pk_bf16_f32 v160, v132, v136
    v_cvt_pk_bf16_f32 v161, v133, v137
    v_mfma_f32_16x16x32_bf16 v[112:115], v[44:47], v[220:223], 0
    v_cvt_pk_bf16_f32 v162, v134, v138
    v_cvt_pk_bf16_f32 v163, v135, v139
    s_waitcnt lgkmcnt(0)
    v_mfma_f32_16x16x32_bf16 v[116:119], v[72:75], v[204:207], 0
    ds_read_b64 v[164:165], v235 offset:256
    ds_read_b64 v[166:167], v235 offset:264
    v_mfma_f32_16x16x32_bf16 v[120:123], v[48:51], v[208:211], 0
    ds_read_b64 v[172:173], v235 offset:128
    ds_read_b64 v[174:175], v235 offset:136
    v_mfma_f32_16x16x32_bf16 v[124:127], v[48:51], v[204:207], 0
    ds_read_b64 v[180:181], v235 offset:0
    ds_read_b64 v[182:183], v235 offset:8
    v_mfma_f32_16x16x32_bf16 v[128:131], v[48:51], v[212:215], 0
    ds_read_b64 v[168:169], v235 offset:272
    ds_read_b64 v[170:171], v235 offset:280
    v_mfma_f32_16x16x32_bf16 v[132:135], v[72:75], v[216:219], 0
    ds_read_b64 v[176:177], v235 offset:144
    ds_read_b64 v[178:179], v235 offset:152
    v_mfma_f32_16x16x32_bf16 v[136:139], v[48:51], v[220:223], 0
    ds_read_b64 v[184:185], v235 offset:16
    ds_read_b64 v[186:187], v235 offset:24
    v_mfma_f32_16x16x32_bf16 v[4:7], v[80:83], v[36:39], 0
    ds_read2_b32 v[188:189], v236 offset0:48 offset1:49
    ds_read2_b32 v[190:191], v236 offset0:50 offset1:51
    v_mfma_f32_16x16x32_bf16 v[8:11], v[80:83], v[40:43], 0
    ds_read2_b32 v[192:193], v236 offset0:32 offset1:33
    ds_read2_b32 v[194:195], v236 offset0:34 offset1:35
    v_mfma_f32_16x16x32_bf16 v[12:15], v[80:83], v[44:47], 0
    ds_read2_b32 v[196:197], v236 offset0:16 offset1:17
    ds_read2_b32 v[198:199], v236 offset0:18 offset1:19
    v_mfma_f32_16x16x32_bf16 v[16:19], v[80:83], v[48:51], 0
    ds_read2_b32 v[200:201], v236 offset0:0 offset1:1
    ds_read2_b32 v[202:203], v236 offset0:2 offset1:3
    v_mfma_f32_16x16x32_bf16 v[20:23], v[80:83], v[52:55], 0
    ds_read_b128 v[68:71], v234 offset:2480
    ds_read_b128 v[72:75], v234 offset:2992
    v_mfma_f32_16x16x32_bf16 v[24:27], v[80:83], v[56:59], 0
    ds_read2_b32 v[84:85], v232 offset0:128 offset1:129
    ds_read2_b32 v[86:87], v232 offset0:130 offset1:131
    v_mfma_f32_16x16x32_bf16 v[28:31], v[80:83], v[60:63], 0
    ds_read2_b32 v[88:89], v232 offset0:0 offset1:1
    ds_read2_b32 v[90:91], v232 offset0:2 offset1:3
    v_mfma_f32_16x16x32_bf16 v[32:35], v[80:83], v[64:67], 0
    v_mul_u32_u24 v76, s63, v76
    v_mul_u32_u24 v77, s63, v77
    s_waitcnt lgkmcnt(15)
    v_mfma_f32_16x16x32_bf16 v[12:15], v[140:143], v[164:167], v[12:15]
    v_mul_u32_u24 v78, s63, v78
    v_mul_u32_u24 v79, s63, v79
    v_mfma_f32_16x16x32_bf16 v[16:19], v[140:143], v[172:175], v[16:19]
    v_mfma_f32_16x16x32_bf16 v[20:23], v[140:143], v[180:183], v[20:23]
    v_mfma_f32_16x16x32_bf16 v[12:15], v[144:147], v[168:171], v[12:15]
    v_mfma_f32_16x16x32_bf16 v[16:19], v[144:147], v[176:179], v[16:19]
    s_waitcnt lgkmcnt(14)
    v_mfma_f32_16x16x32_bf16 v[20:23], v[144:147], v[184:187], v[20:23]
    s_waitcnt lgkmcnt(12)
    v_mfma_f32_16x16x32_bf16 v[20:23], v[148:151], v[188:191], v[20:23]
    s_waitcnt lgkmcnt(10)
    v_mfma_f32_16x16x32_bf16 v[24:27], v[148:151], v[192:195], v[24:27]
    s_waitcnt lgkmcnt(8)
    v_mfma_f32_16x16x32_bf16 v[28:31], v[148:151], v[196:199], v[28:31]
    s_waitcnt lgkmcnt(6)
    v_mfma_f32_16x16x32_bf16 v[32:35], v[148:151], v[200:203], v[32:35]
    v_cvt_pk_bf16_f32 v140, v92, v96
    v_cvt_pk_bf16_f32 v142, v93, v97
    v_mfma_f32_16x16x32_bf16 v[16:19], v[152:155], v[164:167], v[16:19]
    v_cvt_pk_bf16_f32 v144, v94, v98
    v_cvt_pk_bf16_f32 v146, v95, v99
    v_mfma_f32_16x16x32_bf16 v[20:23], v[152:155], v[172:175], v[20:23]
    v_cvt_pk_bf16_f32 v141, v100, v104
    v_cvt_pk_bf16_f32 v143, v101, v105
    v_mfma_f32_16x16x32_bf16 v[24:27], v[152:155], v[180:183], v[24:27]
    v_cvt_pk_bf16_f32 v145, v102, v106
    v_cvt_pk_bf16_f32 v147, v103, v107
    v_mfma_f32_16x16x32_bf16 v[16:19], v[156:159], v[168:171], v[16:19]
    v_cvt_pk_bf16_f32 v148, v108, v112
    v_cvt_pk_bf16_f32 v149, v109, v113
    v_mfma_f32_16x16x32_bf16 v[20:23], v[156:159], v[176:179], v[20:23]
    v_cvt_pk_bf16_f32 v150, v110, v114
    v_cvt_pk_bf16_f32 v151, v111, v115
    v_mfma_f32_16x16x32_bf16 v[24:27], v[156:159], v[184:187], v[24:27]
    v_mfma_f32_16x16x32_bf16 v[24:27], v[160:163], v[188:191], v[24:27]
    v_mfma_f32_16x16x32_bf16 v[28:31], v[160:163], v[192:195], v[28:31]
    v_mfma_f32_16x16x32_bf16 v[32:35], v[160:163], v[196:199], v[32:35]
    v_cvt_pk_bf16_f32 v152, v116, v120
    v_cvt_pk_bf16_f32 v154, v117, v121
    s_waitcnt lgkmcnt(5)
    v_mfma_f32_16x16x32_bf16 v[92:95], v[68:71], v[204:207], 0
    v_cvt_pk_bf16_f32 v156, v118, v122
    v_cvt_pk_bf16_f32 v158, v119, v123
    v_mfma_f32_16x16x32_bf16 v[96:99], v[52:55], v[208:211], 0
    v_cvt_pk_bf16_f32 v153, v124, v128
    v_cvt_pk_bf16_f32 v155, v125, v129
    v_mfma_f32_16x16x32_bf16 v[100:103], v[52:55], v[204:207], 0
    v_cvt_pk_bf16_f32 v157, v126, v130
    v_cvt_pk_bf16_f32 v159, v127, v131
    v_mfma_f32_16x16x32_bf16 v[104:107], v[52:55], v[212:215], 0
    v_cvt_pk_bf16_f32 v160, v132, v136
    v_cvt_pk_bf16_f32 v161, v133, v137
    v_mfma_f32_16x16x32_bf16 v[20:23], v[140:143], v[164:167], v[20:23]
    v_cvt_pk_bf16_f32 v162, v134, v138
    v_cvt_pk_bf16_f32 v163, v135, v139
    v_mfma_f32_16x16x32_bf16 v[24:27], v[140:143], v[172:175], v[24:27]
    v_mfma_f32_16x16x32_bf16 v[28:31], v[140:143], v[180:183], v[28:31]
    v_mfma_f32_16x16x32_bf16 v[20:23], v[144:147], v[168:171], v[20:23]
    v_mfma_f32_16x16x32_bf16 v[24:27], v[144:147], v[176:179], v[24:27]
    v_mfma_f32_16x16x32_bf16 v[28:31], v[144:147], v[184:187], v[28:31]
    v_mfma_f32_16x16x32_bf16 v[28:31], v[148:151], v[188:191], v[28:31]
    v_mfma_f32_16x16x32_bf16 v[32:35], v[148:151], v[192:195], v[32:35]
    v_cvt_pk_bf16_f32 v140, v92, v96
    v_cvt_pk_bf16_f32 v142, v93, v97
    s_waitcnt lgkmcnt(4)
    v_mfma_f32_16x16x32_bf16 v[116:119], v[72:75], v[204:207], 0
    v_cvt_pk_bf16_f32 v144, v94, v98
    v_cvt_pk_bf16_f32 v146, v95, v99
    v_mfma_f32_16x16x32_bf16 v[120:123], v[56:59], v[208:211], 0
    v_cvt_pk_bf16_f32 v141, v100, v104
    v_cvt_pk_bf16_f32 v143, v101, v105
    v_mfma_f32_16x16x32_bf16 v[124:127], v[56:59], v[204:207], 0
    v_cvt_pk_bf16_f32 v145, v102, v106
    v_cvt_pk_bf16_f32 v147, v103, v107
    v_mfma_f32_16x16x32_bf16 v[128:131], v[56:59], v[212:215], 0
    v_mfma_f32_16x16x32_bf16 v[24:27], v[152:155], v[164:167], v[24:27]
    v_mfma_f32_16x16x32_bf16 v[28:31], v[152:155], v[172:175], v[28:31]
    v_mfma_f32_16x16x32_bf16 v[32:35], v[152:155], v[180:183], v[32:35]
    v_mfma_f32_16x16x32_bf16 v[24:27], v[156:159], v[168:171], v[24:27]
    v_mfma_f32_16x16x32_bf16 v[28:31], v[156:159], v[176:179], v[28:31]
    v_mfma_f32_16x16x32_bf16 v[32:35], v[156:159], v[184:187], v[32:35]
    v_mfma_f32_16x16x32_bf16 v[32:35], v[160:163], v[188:191], v[32:35]
    v_cvt_pk_bf16_f32 v152, v116, v120
    v_cvt_pk_bf16_f32 v154, v117, v121
    s_waitcnt lgkmcnt(2)
    v_mfma_f32_16x16x32_bf16 v[8:11], v[84:87], v[36:39], v[8:11]
    v_cvt_pk_bf16_f32 v156, v118, v122
    v_cvt_pk_bf16_f32 v158, v119, v123
    v_mfma_f32_16x16x32_bf16 v[12:15], v[84:87], v[40:43], v[12:15]
    v_cvt_pk_bf16_f32 v153, v124, v128
    v_cvt_pk_bf16_f32 v155, v125, v129
    v_mfma_f32_16x16x32_bf16 v[28:31], v[140:143], v[164:167], v[28:31]
    v_cvt_pk_bf16_f32 v157, v126, v130
    v_cvt_pk_bf16_f32 v159, v127, v131
    v_mfma_f32_16x16x32_bf16 v[32:35], v[140:143], v[172:175], v[32:35]
    ds_read_b128 v[92:95], v234 offset:384
    ds_read_b128 v[96:99], v234 offset:896
    v_mfma_f32_16x16x32_bf16 v[28:31], v[144:147], v[168:171], v[28:31]
    ds_read_b128 v[100:103], v234 offset:1408
    ds_read_b128 v[104:107], v234 offset:1920
    v_mfma_f32_16x16x32_bf16 v[32:35], v[144:147], v[176:179], v[32:35]
    ds_read2_b32 v[140:141], v233 offset0:112 offset1:113
    ds_read2_b32 v[142:143], v233 offset0:114 offset1:115
    v_mfma_f32_16x16x32_bf16 v[16:19], v[84:87], v[44:47], v[16:19]
    ds_read_b128 v[108:111], v234 offset:2432
    ds_read_b128 v[112:115], v234 offset:2944
    v_mfma_f32_16x16x32_bf16 v[20:23], v[84:87], v[48:51], v[20:23]
    ds_read2_b32 v[144:145], v232 offset0:112 offset1:113
    ds_read2_b32 v[146:147], v232 offset0:114 offset1:115
    v_mfma_f32_16x16x32_bf16 v[24:27], v[84:87], v[52:55], v[24:27]
    v_mfma_f32_16x16x32_bf16 v[28:31], v[84:87], v[56:59], v[28:31]
    v_mfma_f32_16x16x32_bf16 v[32:35], v[152:155], v[164:167], v[32:35]
    ds_read_b128 v[116:119], v234 offset:3456
    ds_read_b128 v[120:123], v234 offset:3968
    v_mfma_f32_16x16x32_bf16 v[32:35], v[156:159], v[168:171], v[32:35]
    v_mfma_f32_16x16x32_bf16 v[32:35], v[84:87], v[60:63], v[32:35]
    v_lshrrev_b32 v252, 2, v251
    v_and_b32 v253, 3, v0
    s_waitcnt lgkmcnt(12)
    v_mfma_f32_16x16x32_bf16 v[12:15], v[88:91], v[36:39], v[12:15]
    v_lshlrev_b32 v252, 7, v252
    v_and_b32 v254, 1, v250
    v_mfma_f32_16x16x32_bf16 v[16:19], v[88:91], v[40:43], v[16:19]
    v_lshl_add_u32 v252, v253, 4, v252
    v_lshl_add_u32 v252, v247, 6, v252
    v_mfma_f32_16x16x32_bf16 v[20:23], v[88:91], v[44:47], v[20:23]
    s_lshl_b32 s64, s56, 12
    s_add_u32 s64, s64, 0x290000
    v_mfma_f32_16x16x32_bf16 v[24:27], v[88:91], v[48:51], v[24:27]
    v_lshl_add_u32 v228, v254, 9, v252
    v_lshlrev_b32 v254, 7, v0
    v_mfma_f32_16x16x32_bf16 v[28:31], v[88:91], v[52:55], v[28:31]
    s_mul_i32 s65, s59, 205
    s_lshr_b32 s65, s65, 10
    v_mfma_f32_16x16x32_bf16 v[32:35], v[88:91], v[56:59], v[32:35]
    s_mul_i32 s60, s65, 5
    s_sub_u32 s60, s59, s60
    v_mfma_f32_16x16x32_bf16 v[20:23], v[76:79], v[36:39], v[20:23]
    s_lshl_b32 s65, s65, 12
    s_lshl2_add_u32 s65, s60, s65
    v_mfma_f32_16x16x32_bf16 v[24:27], v[76:79], v[40:43], v[24:27]
    s_add_u32 s65, s65, 0xd60000
    v_min_u32 v220, 59, v0
    v_mfma_f32_16x16x32_bf16 v[28:31], v[76:79], v[44:47], v[28:31]
    s_mul_i32 s36, s3, 6
    v_mul_u32_u24 v221, 6554, v220
    v_mfma_f32_16x16x32_bf16 v[32:35], v[76:79], v[48:51], v[32:35]
    s_lshl_b32 s61, s48, 6
    v_lshrrev_b32 v221, 16, v221
    s_waitcnt lgkmcnt(0)
    v_mfma_f32_16x16x32_bf16 v[4:7], v[140:143], v[92:95], v[4:7]
    ds_read_b128 v[36:39], v234 offset:320
    ds_read2_b32 v[148:149], v233 offset0:96 offset1:97
    v_mfma_f32_16x16x32_bf16 v[8:11], v[140:143], v[96:99], v[8:11]
    ds_read2_b32 v[150:151], v233 offset0:98 offset1:99
    ds_read_b128 v[40:43], v234 offset:832
    v_mfma_f32_16x16x32_bf16 v[12:15], v[140:143], v[100:103], v[12:15]
    ds_read_b128 v[44:47], v234 offset:1344
    ds_read_b128 v[48:51], v234 offset:1856
    v_mfma_f32_16x16x32_bf16 v[16:19], v[140:143], v[104:107], v[16:19]
    ds_read_b128 v[52:55], v234 offset:2368
    ds_read_b128 v[56:59], v234 offset:2880
    v_mfma_f32_16x16x32_bf16 v[20:23], v[140:143], v[108:111], v[20:23]
    ds_read_b128 v[60:63], v234 offset:3392
    ds_read_b128 v[64:67], v234 offset:3904
    v_mfma_f32_16x16x32_bf16 v[24:27], v[140:143], v[112:115], v[24:27]
    ds_read2_b32 v[152:153], v232 offset0:96 offset1:97
    ds_read2_b32 v[154:155], v232 offset0:98 offset1:99
    v_mfma_f32_16x16x32_bf16 v[28:31], v[140:143], v[116:119], v[28:31]
    s_mul_i32 s61, s61, 1280
    v_mul_u32_u24 v222, 10, v221
    v_mfma_f32_16x16x32_bf16 v[32:35], v[140:143], v[120:123], v[32:35]
    s_mul_i32 s62, s49, 160
    v_sub_u32 v220, v220, v222
    v_mfma_f32_16x16x32_bf16 v[8:11], v[144:147], v[92:95], v[8:11]
    s_add_u32 s61, s61, s62
    v_lshlrev_b32 v239, 4, v220
    v_mfma_f32_16x16x32_bf16 v[12:15], v[144:147], v[96:99], v[12:15]
    v_mul_u32_u24 v222, 1280, v221
    v_add3_u32 v238, v222, v239, s61
    v_mfma_f32_16x16x32_bf16 v[16:19], v[144:147], v[100:103], v[16:19]
    s_mul_i32 s32, s36, 1280
    s_add_u32 s33, s32, 30720
    v_mfma_f32_16x16x32_bf16 v[20:23], v[144:147], v[104:107], v[20:23]
    s_mul_i32 s34, s3, 5120
    s_add_u32 s34, s34, 61440
    v_mfma_f32_16x16x32_bf16 v[24:27], v[144:147], v[108:111], v[24:27]
    s_mov_b32 exec_hi, 0x0fffffff
    buffer_load_dwordx4 v[180:183], v238, s[4:7], s32 offen
    s_mov_b32 exec_hi, -1
    s_mov_b32 exec_hi, 0x0fffffff
    buffer_load_dwordx4 v[184:187], v238, s[4:7], s33 offen
    s_mov_b32 exec_hi, -1
    v_mfma_f32_16x16x32_bf16 v[28:31], v[144:147], v[112:115], v[28:31]
    s_mov_b32 exec_hi, 0xff
    buffer_load_dwordx4 v[188:191], v238, s[4:7], s34 offen
    s_mov_b32 exec_hi, -1
    buffer_load_dwordx4 v[192:195], v239, s[24:27], s62 offen
    v_mfma_f32_16x16x32_bf16 v[32:35], v[144:147], v[116:119], v[32:35]
    s_mul_i32 s61, s36, 176
    s_add_u32 s61, s61, 16384
    s_waitcnt lgkmcnt(0)
    v_mfma_f32_16x16x32_bf16 v[4:7], v[148:151], v[36:39], v[4:7]
    ds_read_b128 v[92:95], v234 offset:256
    ds_read2_b32 v[140:141], v233 offset0:80 offset1:81
    v_mfma_f32_16x16x32_bf16 v[8:11], v[148:151], v[40:43], v[8:11]
    ds_read2_b32 v[142:143], v233 offset0:82 offset1:83
    ds_read_b128 v[96:99], v234 offset:768
    v_mfma_f32_16x16x32_bf16 v[12:15], v[148:151], v[44:47], v[12:15]
    ds_read_b128 v[100:103], v234 offset:1280
    ds_read_b128 v[104:107], v234 offset:1792
    v_mfma_f32_16x16x32_bf16 v[16:19], v[148:151], v[48:51], v[16:19]
    ds_read_b128 v[108:111], v234 offset:2304
    ds_read_b128 v[112:115], v234 offset:2816
    v_mfma_f32_16x16x32_bf16 v[20:23], v[148:151], v[52:55], v[20:23]
    ds_read_b128 v[116:119], v234 offset:3328
    ds_read_b128 v[120:123], v234 offset:3840
    v_mfma_f32_16x16x32_bf16 v[24:27], v[148:151], v[56:59], v[24:27]
    ds_read2_b32 v[144:145], v232 offset0:80 offset1:81
    ds_read2_b32 v[146:147], v232 offset0:82 offset1:83
    v_mfma_f32_16x16x32_bf16 v[28:31], v[148:151], v[60:63], v[28:31]
    v_mul_u32_u24 v222, 176, v221
    v_add3_u32 v244, v222, v239, s61
    v_mfma_f32_16x16x32_bf16 v[32:35], v[148:151], v[64:67], v[32:35]
    s_mul_i32 s61, s36, 336
    s_add_u32 s61, s61, 77824
    v_mfma_f32_16x16x32_bf16 v[8:11], v[152:155], v[36:39], v[8:11]
    v_mul_u32_u24 v222, 336, v221
    v_lshl_add_u32 v222, v220, 5, v222
    v_mfma_f32_16x16x32_bf16 v[12:15], v[152:155], v[40:43], v[12:15]
    v_add_u32 v240, s61, v222
    v_add_u32 v241, 43008, v240
    v_mfma_f32_16x16x32_bf16 v[16:19], v[152:155], v[44:47], v[16:19]
    s_mul_i32 s61, s3, 672
    v_subrev_u32 v242, s61, v240
    v_mfma_f32_16x16x32_bf16 v[20:23], v[152:155], v[48:51], v[20:23]
    v_subrev_u32 v243, s61, v241
    s_mul_i32 s61, s3, 352
    v_mfma_f32_16x16x32_bf16 v[24:27], v[152:155], v[52:55], v[24:27]
    v_subrev_u32 v224, s61, v244
    v_lshrrev_b32 v220, 3, v0
    v_mfma_f32_16x16x32_bf16 v[28:31], v[152:155], v[56:59], v[28:31]
    v_mul_u32_u24 v220, 3968, v220
    v_add_u32 v229, v220, v248
    v_mfma_f32_16x16x32_bf16 v[32:35], v[152:155], v[60:63], v[32:35]
    v_add_u32 v230, 0x8000, v229
    v_add_u32 v231, 0x10000, v229
    s_waitcnt lgkmcnt(0)
    v_mfma_f32_16x16x32_bf16 v[4:7], v[140:143], v[92:95], v[4:7]
    ds_read_b128 v[36:39], v234 offset:192
    ds_read2_b32 v[148:149], v233 offset0:64 offset1:65
    v_mfma_f32_16x16x32_bf16 v[8:11], v[140:143], v[96:99], v[8:11]
    ds_read2_b32 v[150:151], v233 offset0:66 offset1:67
    ds_read_b128 v[40:43], v234 offset:704
    v_mfma_f32_16x16x32_bf16 v[12:15], v[140:143], v[100:103], v[12:15]
    ds_read_b128 v[44:47], v234 offset:1216
    ds_read_b128 v[48:51], v234 offset:1728
    v_mfma_f32_16x16x32_bf16 v[16:19], v[140:143], v[104:107], v[16:19]
    ds_read_b128 v[52:55], v234 offset:2240
    ds_read_b128 v[56:59], v234 offset:2752
    v_mfma_f32_16x16x32_bf16 v[20:23], v[140:143], v[108:111], v[20:23]
    ds_read_b128 v[60:63], v234 offset:3264
    ds_read_b128 v[64:67], v234 offset:3776
    v_mfma_f32_16x16x32_bf16 v[24:27], v[140:143], v[112:115], v[24:27]
    ds_read2_b32 v[152:153], v232 offset0:64 offset1:65
    ds_read2_b32 v[154:155], v232 offset0:66 offset1:67
    v_mfma_f32_16x16x32_bf16 v[28:31], v[140:143], v[116:119], v[28:31]
    v_lshrrev_b32 v220, 2, v251
    v_and_b32 v221, 2, v0
    v_mfma_f32_16x16x32_bf16 v[32:35], v[140:143], v[120:123], v[32:35]
    v_lshlrev_b32 v220, 7, v220
    v_and_b32 v222, 1, v0
    v_mfma_f32_16x16x32_bf16 v[8:11], v[144:147], v[92:95], v[8:11]
    v_lshl_add_u32 v220, v221, 5, v220
    v_lshl_add_u32 v220, v250, 4, v220
    v_mfma_f32_16x16x32_bf16 v[12:15], v[144:147], v[96:99], v[12:15]
    v_lshl_add_u32 v220, v222, 3, v220
    v_add_u32 v225, s70, v220
    v_mfma_f32_16x16x32_bf16 v[16:19], v[144:147], v[100:103], v[16:19]
    s_mul_i32 s61, s3, 40
    s_add_u32 s61, s61, 16384
    v_mfma_f32_16x16x32_bf16 v[20:23], v[144:147], v[104:107], v[20:23]
    v_mul_u32_u24 v220, 176, v0
    v_add_u32 v226, s61, v220
    v_mfma_f32_16x16x32_bf16 v[24:27], v[144:147], v[108:111], v[24:27]
    s_lshl2_add_u32 s38, s49, s3
    s_mul_i32 s37, s38, 81920
    v_mfma_f32_16x16x32_bf16 v[28:31], v[144:147], v[112:115], v[28:31]
    s_lshl_b32 s61, s48, 7
    s_add_u32 s37, s37, s61
    v_mfma_f32_16x16x32_bf16 v[32:35], v[144:147], v[116:119], v[32:35]
    s_add_u32 s37, s37, 0x290000
    s_lshl_b32 s38, s38, 12
    s_waitcnt lgkmcnt(0)
    v_mfma_f32_16x16x32_bf16 v[4:7], v[148:151], v[36:39], v[4:7]
    ds_read_b128 v[92:95], v234 offset:128
    ds_read2_b32 v[140:141], v233 offset0:48 offset1:49
    v_mfma_f32_16x16x32_bf16 v[8:11], v[148:151], v[40:43], v[8:11]
    ds_read2_b32 v[142:143], v233 offset0:50 offset1:51
    ds_read_b128 v[96:99], v234 offset:640
    v_mfma_f32_16x16x32_bf16 v[12:15], v[148:151], v[44:47], v[12:15]
    ds_read_b128 v[100:103], v234 offset:1152
    ds_read_b128 v[104:107], v234 offset:1664
    v_mfma_f32_16x16x32_bf16 v[16:19], v[148:151], v[48:51], v[16:19]
    ds_read_b128 v[108:111], v234 offset:2176
    ds_read_b128 v[112:115], v234 offset:2688
    v_mfma_f32_16x16x32_bf16 v[20:23], v[148:151], v[52:55], v[20:23]
    ds_read_b128 v[116:119], v234 offset:3200
    ds_read_b128 v[120:123], v234 offset:3712
    v_mfma_f32_16x16x32_bf16 v[24:27], v[148:151], v[56:59], v[24:27]
    ds_read2_b32 v[144:145], v232 offset0:48 offset1:49
    ds_read2_b32 v[146:147], v232 offset0:50 offset1:51
    v_mfma_f32_16x16x32_bf16 v[28:31], v[148:151], v[60:63], v[28:31]
    s_add_u32 s38, s38, s61
    s_add_u32 s38, s38, 0xd60000
    v_mfma_f32_16x16x32_bf16 v[32:35], v[148:151], v[64:67], v[32:35]
    v_mfma_f32_16x16x32_bf16 v[8:11], v[152:155], v[36:39], v[8:11]
    v_mfma_f32_16x16x32_bf16 v[12:15], v[152:155], v[40:43], v[12:15]
    v_mfma_f32_16x16x32_bf16 v[16:19], v[152:155], v[44:47], v[16:19]
    v_mfma_f32_16x16x32_bf16 v[20:23], v[152:155], v[48:51], v[20:23]
    v_mfma_f32_16x16x32_bf16 v[24:27], v[152:155], v[52:55], v[24:27]
    v_mfma_f32_16x16x32_bf16 v[28:31], v[152:155], v[56:59], v[28:31]
    v_mfma_f32_16x16x32_bf16 v[32:35], v[152:155], v[60:63], v[32:35]
    s_waitcnt lgkmcnt(0)
    v_mfma_f32_16x16x32_bf16 v[4:7], v[140:143], v[92:95], v[4:7]
    ds_read_b128 v[36:39], v234 offset:64
    ds_read2_b32 v[148:149], v233 offset0:32 offset1:33
    v_mfma_f32_16x16x32_bf16 v[8:11], v[140:143], v[96:99], v[8:11]
    ds_read2_b32 v[150:151], v233 offset0:34 offset1:35
    ds_read_b128 v[40:43], v234 offset:576
    v_mfma_f32_16x16x32_bf16 v[12:15], v[140:143], v[100:103], v[12:15]
    ds_read_b128 v[44:47], v234 offset:1088
    ds_read_b128 v[48:51], v234 offset:1600
    v_mfma_f32_16x16x32_bf16 v[16:19], v[140:143], v[104:107], v[16:19]
    ds_read_b128 v[52:55], v234 offset:2112
    ds_read_b128 v[56:59], v234 offset:2624
    v_mfma_f32_16x16x32_bf16 v[20:23], v[140:143], v[108:111], v[20:23]
    ds_read_b128 v[60:63], v234 offset:3136
    ds_read_b128 v[64:67], v234 offset:3648
    v_mfma_f32_16x16x32_bf16 v[24:27], v[140:143], v[112:115], v[24:27]
    ds_read2_b32 v[152:153], v232 offset0:32 offset1:33
    ds_read2_b32 v[154:155], v232 offset0:34 offset1:35
    v_mfma_f32_16x16x32_bf16 v[28:31], v[140:143], v[116:119], v[28:31]
    s_waitcnt vmcnt(0)
    v_lshlrev_b32 v220, 16, v192
    v_and_b32 v221, 0xffff0000, v192
    v_mfma_f32_16x16x32_bf16 v[32:35], v[140:143], v[120:123], v[32:35]
    v_lshlrev_b32 v196, 16, v180
    v_and_b32 v197, 0xffff0000, v180
    v_mfma_f32_16x16x32_bf16 v[8:11], v[144:147], v[92:95], v[8:11]
    v_add_f32 v196, v196, v220
    v_add_f32 v197, v197, v221
    v_mfma_f32_16x16x32_bf16 v[12:15], v[144:147], v[96:99], v[12:15]
    v_lshlrev_b32 v204, 16, v184
    v_and_b32 v205, 0xffff0000, v184
    v_mfma_f32_16x16x32_bf16 v[16:19], v[144:147], v[100:103], v[16:19]
    v_add_f32 v204, v204, v220
    v_add_f32 v205, v205, v221
    v_mfma_f32_16x16x32_bf16 v[20:23], v[144:147], v[104:107], v[20:23]
    v_lshlrev_b32 v212, 16, v188
    v_and_b32 v213, 0xffff0000, v188
    v_mfma_f32_16x16x32_bf16 v[24:27], v[144:147], v[108:111], v[24:27]
    v_add_f32 v212, v212, v220
    v_add_f32 v213, v213, v221
    v_mfma_f32_16x16x32_bf16 v[28:31], v[144:147], v[112:115], v[28:31]
    v_lshlrev_b32 v220, 16, v193
    v_and_b32 v221, 0xffff0000, v193
    v_mfma_f32_16x16x32_bf16 v[32:35], v[144:147], v[116:119], v[32:35]
    v_lshlrev_b32 v198, 16, v181
    v_and_b32 v199, 0xffff0000, v181
    s_waitcnt lgkmcnt(0)
    v_mfma_f32_16x16x32_bf16 v[4:7], v[148:151], v[36:39], v[4:7]
    ds_read_b128 v[92:95], v234 offset:0
    ds_read2_b32 v[140:141], v233 offset0:16 offset1:17
    v_mfma_f32_16x16x32_bf16 v[8:11], v[148:151], v[40:43], v[8:11]
    ds_read2_b32 v[142:143], v233 offset0:18 offset1:19
    ds_read2_b32 v[144:145], v232 offset0:16 offset1:17
    v_mfma_f32_16x16x32_bf16 v[12:15], v[148:151], v[44:47], v[12:15]
    ds_read2_b32 v[146:147], v232 offset0:18 offset1:19
    ds_read_b128 v[96:99], v234 offset:512
    v_mfma_f32_16x16x32_bf16 v[16:19], v[148:151], v[48:51], v[16:19]
    ds_read_b128 v[100:103], v234 offset:1024
    ds_read_b128 v[104:107], v234 offset:1536
    v_mfma_f32_16x16x32_bf16 v[20:23], v[148:151], v[52:55], v[20:23]
    ds_read_b128 v[108:111], v234 offset:2048
    ds_read_b128 v[112:115], v234 offset:2560
    v_mfma_f32_16x16x32_bf16 v[24:27], v[148:151], v[56:59], v[24:27]
    ds_read_b128 v[116:119], v234 offset:3072
    ds_read_b128 v[120:123], v234 offset:3584
    v_mfma_f32_16x16x32_bf16 v[28:31], v[148:151], v[60:63], v[28:31]
    v_add_f32 v198, v198, v220
    v_add_f32 v199, v199, v221
    v_mfma_f32_16x16x32_bf16 v[32:35], v[148:151], v[64:67], v[32:35]
    v_lshlrev_b32 v206, 16, v185
    v_and_b32 v207, 0xffff0000, v185
    v_mfma_f32_16x16x32_bf16 v[8:11], v[152:155], v[36:39], v[8:11]
    v_add_f32 v206, v206, v220
    v_add_f32 v207, v207, v221
    v_mfma_f32_16x16x32_bf16 v[12:15], v[152:155], v[40:43], v[12:15]
    v_lshlrev_b32 v214, 16, v189
    v_and_b32 v215, 0xffff0000, v189
    v_mfma_f32_16x16x32_bf16 v[16:19], v[152:155], v[44:47], v[16:19]
    v_add_f32 v214, v214, v220
    v_add_f32 v215, v215, v221
    v_mfma_f32_16x16x32_bf16 v[20:23], v[152:155], v[48:51], v[20:23]
    v_lshlrev_b32 v220, 16, v194
    v_and_b32 v221, 0xffff0000, v194
    v_mfma_f32_16x16x32_bf16 v[24:27], v[152:155], v[52:55], v[24:27]
    v_lshlrev_b32 v200, 16, v182
    v_and_b32 v201, 0xffff0000, v182
    v_mfma_f32_16x16x32_bf16 v[28:31], v[152:155], v[56:59], v[28:31]
    v_add_f32 v200, v200, v220
    v_add_f32 v201, v201, v221
    v_mfma_f32_16x16x32_bf16 v[32:35], v[152:155], v[60:63], v[32:35]
    v_lshlrev_b32 v208, 16, v186
    v_and_b32 v209, 0xffff0000, v186
    s_waitcnt lgkmcnt(0)
    v_mfma_f32_16x16x32_bf16 v[4:7], v[140:143], v[92:95], v[4:7]
    v_add_f32 v208, v208, v220
    v_add_f32 v209, v209, v221
    v_mfma_f32_16x16x32_bf16 v[8:11], v[140:143], v[96:99], v[8:11]
    v_lshlrev_b32 v216, 16, v190
    v_and_b32 v217, 0xffff0000, v190
    v_mfma_f32_16x16x32_bf16 v[8:11], v[144:147], v[92:95], v[8:11]
    v_mfma_f32_16x16x32_bf16 v[12:15], v[140:143], v[100:103], v[12:15]
    v_mfma_f32_16x16x32_bf16 v[16:19], v[140:143], v[104:107], v[16:19]
    v_mfma_f32_16x16x32_bf16 v[12:15], v[144:147], v[96:99], v[12:15]
    v_mfma_f32_16x16x32_bf16 v[16:19], v[144:147], v[100:103], v[16:19]
    v_cvt_pk_bf16_f32 v164, v4, v5
    v_cvt_pk_bf16_f32 v165, v6, v7
    v_mfma_f32_16x16x32_bf16 v[20:23], v[140:143], v[108:111], v[20:23]
    s_nop 0
    v_cvt_pk_bf16_f32 v166, v8, v9
    v_cvt_pk_bf16_f32 v167, v10, v11
    v_mfma_f32_16x16x32_bf16 v[24:27], v[140:143], v[112:115], v[24:27]
    v_permlane16_swap_b32 v164, v166
    v_permlane16_swap_b32 v165, v167
    v_mfma_f32_16x16x32_bf16 v[20:23], v[144:147], v[104:107], v[20:23]
    buffer_store_dwordx4 v[164:167], v228, s[12:15], s64 offen offset:0 sc1
    v_mfma_f32_16x16x32_bf16 v[24:27], v[144:147], v[108:111], v[24:27]
    v_cvt_pk_bf16_f32 v168, v12, v13
    v_cvt_pk_bf16_f32 v169, v14, v15
    v_mfma_f32_16x16x32_bf16 v[28:31], v[140:143], v[116:119], v[28:31]
    v_cvt_pk_bf16_f32 v170, v16, v17
    v_cvt_pk_bf16_f32 v171, v18, v19
    v_mfma_f32_16x16x32_bf16 v[32:35], v[140:143], v[120:123], v[32:35]
    v_permlane16_swap_b32 v168, v170
    v_permlane16_swap_b32 v169, v171
    v_mfma_f32_16x16x32_bf16 v[28:31], v[144:147], v[112:115], v[28:31]
    buffer_store_dwordx4 v[168:171], v228, s[12:15], s64 offen offset:1024 sc1
    v_mfma_f32_16x16x32_bf16 v[32:35], v[144:147], v[116:119], v[32:35]
    v_cvt_pk_bf16_f32 v172, v20, v21
    v_cvt_pk_bf16_f32 v173, v22, v23
    v_cvt_pk_bf16_f32 v174, v24, v25
    v_cvt_pk_bf16_f32 v175, v26, v27
    s_nop 0
    v_permlane16_swap_b32 v172, v174
    v_permlane16_swap_b32 v173, v175
    buffer_store_dwordx4 v[172:175], v228, s[12:15], s64 offen offset:2048 sc1
    v_cvt_pk_bf16_f32 v176, v28, v29
    v_cvt_pk_bf16_f32 v177, v30, v31
    v_cvt_pk_bf16_f32 v178, v32, v33
    v_cvt_pk_bf16_f32 v179, v34, v35
    s_nop 0
    v_permlane16_swap_b32 v176, v178
    v_permlane16_swap_b32 v177, v179
    buffer_store_dwordx4 v[176:179], v228, s[12:15], s64 offen offset:3072 sc1
    v_add_f32 v216, v216, v220
    v_add_f32 v217, v217, v221
    v_lshlrev_b32 v220, 16, v195
    v_and_b32 v221, 0xffff0000, v195
    v_lshlrev_b32 v202, 16, v183
    v_and_b32 v203, 0xffff0000, v183
    v_add_f32 v202, v202, v220
    v_add_f32 v203, v203, v221
    v_lshlrev_b32 v210, 16, v187
    v_and_b32 v211, 0xffff0000, v187
    v_add_f32 v210, v210, v220
    v_add_f32 v211, v211, v221
    v_lshlrev_b32 v218, 16, v191
    v_and_b32 v219, 0xffff0000, v191
    v_add_f32 v218, v218, v220
    v_add_f32 v219, v219, v221
    s_waitcnt vmcnt(0)
    s_mov_b64 exec, 1
    ds_add_rtn_u32 v253, v227, v245 offset:4
    s_waitcnt lgkmcnt(0)
    v_readfirstlane_b32 s60, v253
    s_mov_b64 exec, -1
    s_cmp_eq_u32 s60, 3
    s_cbranch_scc0 ys_14
    s_mov_b32 exec_hi, 0
    buffer_store_dword v245, v254, s[12:15], s65 offen sc1
    s_mov_b64 exec, -1
ys_14:
    s_mov_b32 s76, 0
    s_branch lw_15f
lw_15:
    s_sleep 1
    s_add_u32 s76, s76, 1
    s_cmp_gt_u32 s76, 1600000
    s_cbranch_scc1 lx_16
lw_15f:
    ds_read_b32 v253, v227 offset:4
    s_waitcnt lgkmcnt(0)
    v_readfirstlane_b32 s60, v253
    s_cmp_lt_u32 s60, 4
    s_cbranch_scc1 lw_15
lx_16:
h_fin:
    s_setprio 0
    s_mov_b32 s76, 0
    s_branch YF_17f
YF_17:
    s_sleep 4
    s_add_u32 s76, s76, 1
    s_cmp_gt_u32 s76, 200000
    s_cbranch_scc1 YFx_18
YF_17f:
    s_load_dwordx8 s[40:47], s[12:13], s38 glc
    s_waitcnt lgkmcnt(0)
    s_and_b64 s[40:41], s[40:41], s[42:43]
    s_and_b32 s40, s40, s41
    s_and_b32 s40, s40, s44
    s_cmp_eq_u32 s40, 1
    s_cbranch_scc0 YF_17
YFx_18:
    s_add_u32 m0, s70, 0
    s_nop 0
    buffer_load_dwordx4 v229, s[12:15], s37 offen sc1 lds
    s_add_u32 m0, s70, 1024
    s_nop 0
    buffer_load_dwordx4 v230, s[12:15], s37 offen sc1 lds
    s_mov_b32 exec_hi, 0
    s_add_u32 m0, s70, 2048
    s_nop 0
    buffer_load_dwordx4 v231, s[12:15], s37 offen sc1 lds
    s_mov_b32 exec_hi, -1
    s_waitcnt vmcnt(0)
    ds_read_b64_tr_b16 v[180:181], v225 offset:0
    ds_read_b64_tr_b16 v[182:183], v225 offset:512
    ds_read_b64_tr_b16 v[184:185], v225 offset:1024
    ds_read_b64_tr_b16 v[186:187], v225 offset:1536
    ds_read_b64_tr_b16 v[188:189], v225 offset:2048
    s_waitcnt lgkmcnt(4)
    ds_write_b64 v226, v[180:181] offset:0
    s_waitcnt lgkmcnt(4)
    ds_write_b64 v226, v[182:183] offset:8
    s_waitcnt lgkmcnt(4)
    ds_write_b64 v226, v[184:185] offset:16
    s_waitcnt lgkmcnt(4)
    ds_write_b64 v226, v[186:187] offset:24
    s_waitcnt lgkmcnt(4)
    ds_write_b64 v226, v[188:189] offset:32
    s_mov_b64 exec, 1
    ds_add_u32 v227, v245 offset:8
    s_mov_b64 exec, -1
    s_mov_b32 s76, 0
    s_branch lw_19f
lw_19:
    s_sleep 1
    s_add_u32 s76, s76, 1
    s_cmp_gt_u32 s76, 1600000
    s_cbranch_scc1 lx_20
lw_19f:
    ds_read_b32 v253, v227 offset:8
    s_waitcnt lgkmcnt(0)
    v_readfirstlane_b32 s60, v253
    s_cmp_lt_u32 s60, 4
    s_cbranch_scc1 lw_19
lx_20:
    ds_read_b128 v[92:95], v244 offset:0
    ds_read_b128 v[96:99], v244 offset:4224
    ds_read_b128 v[100:103], v224 offset:8448
    s_waitcnt lgkmcnt(2)
    v_lshlrev_b32 v220, 16, v92
    v_and_b32 v221, 0xffff0000, v92
    v_add_f32 v196, v196, v220
    v_add_f32 v197, v197, v221
    v_lshlrev_b32 v220, 16, v93
    v_and_b32 v221, 0xffff0000, v93
    v_add_f32 v198, v198, v220
    v_add_f32 v199, v199, v221
    v_lshlrev_b32 v220, 16, v94
    v_and_b32 v221, 0xffff0000, v94
    v_add_f32 v200, v200, v220
    v_add_f32 v201, v201, v221
    v_lshlrev_b32 v220, 16, v95
    v_and_b32 v221, 0xffff0000, v95
    v_add_f32 v202, v202, v220
    v_add_f32 v203, v203, v221
    s_waitcnt lgkmcnt(1)
    v_lshlrev_b32 v220, 16, v96
    v_and_b32 v221, 0xffff0000, v96
    v_add_f32 v204, v204, v220
    v_add_f32 v205, v205, v221
    v_lshlrev_b32 v220, 16, v97
    v_and_b32 v221, 0xffff0000, v97
    v_add_f32 v206, v206, v220
    v_add_f32 v207, v207, v221
    v_lshlrev_b32 v220, 16, v98
    v_and_b32 v221, 0xffff0000, v98
    v_add_f32 v208, v208, v220
    v_add_f32 v209, v209, v221
    v_lshlrev_b32 v220, 16, v99
    v_and_b32 v221, 0xffff0000, v99
    v_add_f32 v210, v210, v220
    v_add_f32 v211, v211, v221
    s_waitcnt lgkmcnt(0)
    v_lshlrev_b32 v220, 16, v100
    v_and_b32 v221, 0xffff0000, v100
    v_add_f32 v212, v212, v220
    v_add_f32 v213, v213, v221
    v_lshlrev_b32 v220, 16, v101
    v_and_b32 v221, 0xffff0000, v101
    v_add_f32 v214, v214, v220
    v_add_f32 v215, v215, v221
    v_lshlrev_b32 v220, 16, v102
    v_and_b32 v221, 0xffff0000, v102
    v_add_f32 v216, v216, v220
    v_add_f32 v217, v217, v221
    v_lshlrev_b32 v220, 16, v103
    v_and_b32 v221, 0xffff0000, v103
    v_add_f32 v218, v218, v220
    v_add_f32 v219, v219, v221
    s_mov_b32 s76, 0
    s_branch lw_21f
lw_21:
    s_sleep 1
    s_add_u32 s76, s76, 1
    s_cmp_gt_u32 s76, 1600000
    s_cbranch_scc1 lx_22
lw_21f:
    ds_read_b32 v253, v227 offset:20
    s_waitcnt lgkmcnt(0)
    v_readfirstlane_b32 s60, v253
    s_cmp_lt_u32 s60, 4
    s_cbranch_scc1 lw_21
lx_22:
    ds_read_b128 v[108:111], v240 offset:0
    ds_read_b128 v[112:115], v240 offset:16
    ds_read_b128 v[116:119], v240 offset:21504
    ds_read_b128 v[120:123], v240 offset:21520
    ds_read_b128 v[124:127], v241 offset:0
    ds_read_b128 v[128:131], v241 offset:16
    ds_read_b128 v[132:135], v241 offset:21504
    ds_read_b128 v[136:139], v241 offset:21520
    s_waitcnt lgkmcnt(7)
    v_add_f32 v196, v196, v108
    v_add_f32 v197, v197, v109
    v_add_f32 v198, v198, v110
    v_add_f32 v199, v199, v111
    s_waitcnt lgkmcnt(6)
    v_add_f32 v200, v200, v112
    v_add_f32 v201, v201, v113
    v_add_f32 v202, v202, v114
    v_add_f32 v203, v203, v115
    s_waitcnt lgkmcnt(5)
    v_add_f32 v196, v196, v116
    v_add_f32 v197, v197, v117
    v_add_f32 v198, v198, v118
    v_add_f32 v199, v199, v119
    s_waitcnt lgkmcnt(4)
    v_add_f32 v200, v200, v120
    v_add_f32 v201, v201, v121
    v_add_f32 v202, v202, v122
    v_add_f32 v203, v203, v123
    s_waitcnt lgkmcnt(3)
    v_add_f32 v196, v196, v124
    v_add_f32 v197, v197, v125
    v_add_f32 v198, v198, v126
    v_add_f32 v199, v199, v127
    s_waitcnt lgkmcnt(2)
    v_add_f32 v200, v200, v128
    v_add_f32 v201, v201, v129
    v_add_f32 v202, v202, v130
    v_add_f32 v203, v203, v131
    s_waitcnt lgkmcnt(1)
    v_add_f32 v196, v196, v132
    v_add_f32 v197, v197, v133
    v_add_f32 v198, v198, v134
    v_add_f32 v199, v199, v135
    s_waitcnt lgkmcnt(0)
    v_add_f32 v200, v200, v136
    v_add_f32 v201, v201, v137
    v_add_f32 v202, v202, v138
    v_add_f32 v203, v203, v139
    v_cvt_pk_bf16_f32 v180, v196, v197
    v_cvt_pk_bf16_f32 v181, v198, v199
    v_cvt_pk_bf16_f32 v182, v200, v201
    v_cvt_pk_bf16_f32 v183, v202, v203
    s_mov_b32 exec_hi, 0x0fffffff
    buffer_store_dwordx4 v[180:183], v238, s[16:19], s32 offen sc1
    s_mov_b32 exec_hi, -1
    s_mov_b32 s76, 0
    s_branch lw_23f
lw_23:
    s_sleep 1
    s_add_u32 s76, s76, 1
    s_cmp_gt_u32 s76, 1600000
    s_cbranch_scc1 lx_24
lw_23f:
    ds_read_b32 v253, v227 offset:24
    s_waitcnt lgkmcnt(0)
    v_readfirstlane_b32 s60, v253
    s_cmp_lt_u32 s60, 4
    s_cbranch_scc1 lw_23
lx_24:
    ds_read_b128 v[140:143], v240 offset:8064
    ds_read_b128 v[144:147], v240 offset:8080
    ds_read_b128 v[148:151], v240 offset:29568
    ds_read_b128 v[152:155], v240 offset:29584
    ds_read_b128 v[156:159], v241 offset:8064
    ds_read_b128 v[160:163], v241 offset:8080
    ds_read_b128 v[164:167], v241 offset:29568
    ds_read_b128 v[168:171], v241 offset:29584
    s_waitcnt lgkmcnt(7)
    v_add_f32 v204, v204, v140
    v_add_f32 v205, v205, v141
    v_add_f32 v206, v206, v142
    v_add_f32 v207, v207, v143
    s_waitcnt lgkmcnt(6)
    v_add_f32 v208, v208, v144
    v_add_f32 v209, v209, v145
    v_add_f32 v210, v210, v146
    v_add_f32 v211, v211, v147
    s_waitcnt lgkmcnt(5)
    v_add_f32 v204, v204, v148
    v_add_f32 v205, v205, v149
    v_add_f32 v206, v206, v150
    v_add_f32 v207, v207, v151
    s_waitcnt lgkmcnt(4)
    v_add_f32 v208, v208, v152
    v_add_f32 v209, v209, v153
    v_add_f32 v210, v210, v154
    v_add_f32 v211, v211, v155
    s_waitcnt lgkmcnt(3)
    v_add_f32 v204, v204, v156
    v_add_f32 v205, v205, v157
    v_add_f32 v206, v206, v158
    v_add_f32 v207, v207, v159
    s_waitcnt lgkmcnt(2)
    v_add_f32 v208, v208, v160
    v_add_f32 v209, v209, v161
    v_add_f32 v210, v210, v162
    v_add_f32 v211, v211, v163
    s_waitcnt lgkmcnt(1)
    v_add_f32 v204, v204, v164
    v_add_f32 v205, v205, v165
    v_add_f32 v206, v206, v166
    v_add_f32 v207, v207, v167
    s_waitcnt lgkmcnt(0)
    v_add_f32 v208, v208, v168
    v_add_f32 v209, v209, v169
    v_add_f32 v210, v210, v170
    v_add_f32 v211, v211, v171
    v_cvt_pk_bf16_f32 v184, v204, v205
    v_cvt_pk_bf16_f32 v185, v206, v207
    v_cvt_pk_bf16_f32 v186, v208, v209
    v_cvt_pk_bf16_f32 v187, v210, v211
    s_mov_b32 exec_hi, 0x0fffffff
    buffer_store_dwordx4 v[184:187], v238, s[16:19], s33 offen sc1
    s_mov_b32 exec_hi, -1
    s_mov_b32 s76, 0
    s_branch lw_25f
lw_25:
    s_sleep 1
    s_add_u32 s76, s76, 1
    s_cmp_gt_u32 s76, 1600000
    s_cbranch_scc1 lx_26
lw_25f:
    ds_read_b32 v253, v227 offset:28
    s_waitcnt lgkmcnt(0)
    v_readfirstlane_b32 s60, v253
    s_cmp_lt_u32 s60, 4
    s_cbranch_scc1 lw_25
lx_26:
    ds_read_b128 v[108:111], v242 offset:16128
    ds_read_b128 v[112:115], v242 offset:16144
    ds_read_b128 v[116:119], v242 offset:37632
    ds_read_b128 v[120:123], v242 offset:37648
    ds_read_b128 v[124:127], v243 offset:16128
    ds_read_b128 v[128:131], v243 offset:16144
    ds_read_b128 v[132:135], v243 offset:37632
    ds_read_b128 v[136:139], v243 offset:37648
    s_waitcnt lgkmcnt(7)
    v_pk_add_f32 v[212:213], v[212:213], v[108:109]
    v_pk_add_f32 v[214:215], v[214:215], v[110:111]
    s_waitcnt lgkmcnt(6)
    v_pk_add_f32 v[216:217], v[216:217], v[112:113]
    v_pk_add_f32 v[218:219], v[218:219], v[114:115]
    s_waitcnt lgkmcnt(5)
    v_pk_add_f32 v[212:213], v[212:213], v[116:117]
    v_pk_add_f32 v[214:215], v[214:215], v[118:119]
    s_waitcnt lgkmcnt(4)
    v_pk_add_f32 v[216:217], v[216:217], v[120:121]
    v_pk_add_f32 v[218:219], v[218:219], v[122:123]
    s_waitcnt lgkmcnt(3)
    v_pk_add_f32 v[212:213], v[212:213], v[124:125]
    v_pk_add_f32 v[214:215], v[214:215], v[126:127]
    s_waitcnt lgkmcnt(2)
    v_pk_add_f32 v[216:217], v[216:217], v[128:129]
    v_pk_add_f32 v[218:219], v[218:219], v[130:131]
    s_waitcnt lgkmcnt(1)
    v_pk_add_f32 v[212:213], v[212:213], v[132:133]
    v_pk_add_f32 v[214:215], v[214:215], v[134:135]
    s_waitcnt lgkmcnt(0)
    v_pk_add_f32 v[216:217], v[216:217], v[136:137]
    v_pk_add_f32 v[218:219], v[218:219], v[138:139]
    v_cvt_pk_bf16_f32 v188, v212, v213
    v_cvt_pk_bf16_f32 v189, v214, v215
    v_cvt_pk_bf16_f32 v190, v216, v217
    v_cvt_pk_bf16_f32 v191, v218, v219
    s_mov_b32 exec_hi, 0xff
    buffer_store_dwordx4 v[188:191], v238, s[16:19], s34 offen sc1
    s_mov_b32 exec_hi, -1
    s_endpgm
.p2align 6
role_a:
    s_and_b32 s59, s2, 7
    s_lshl_b32 s59, s59, 5
    s_lshr_b32 s60, s2, 3
    s_add_u32 s59, s59, s60
    s_sub_u32 s59, s59, 20
    s_cmp_lt_u32 s60, 28
    s_cselect_b32 s71, 3, 2
    s_cselect_b32 s62, 122880, 0
    s_cmp_lt_u32 s77, 4
    s_cbranch_scc1 a_c
    s_sub_u32 s72, s2, 160
    s_and_b32 s61, s72, 1
    s_lshr_b32 s60, s72, 1
    s_lshl2_add_u32 s62, s60, s3
    s_lshl4_add_u32 s62, s62, s61
    s_mul_i32 s62, s62, 640
    s_mul_i32 s63, s3, 5120
    v_lshrrev_b32 v252, 3, v0
    v_mul_u32_u24 v252, 1152, v252
    v_add3_u32 v1, v252, v248, s62
    s_add_u32 m0, s63, 40960
    s_waitcnt lgkmcnt(0)
    global_load_lds_dwordx4 v1, s[16:17] offset:0
    s_add_u32 m0, s63, 41856
    s_nop 0
    global_load_lds_dwordx4 v1, s[16:17] offset:128
    s_add_u32 m0, s63, 42752
    s_nop 0
    global_load_lds_dwordx4 v1, s[16:17] offset:256
    s_add_u32 m0, s63, 43648
    s_nop 0
    global_load_lds_dwordx4 v1, s[16:17] offset:384
    s_add_u32 m0, s63, 44544
    s_nop 0
    global_load_lds_dwordx4 v1, s[16:17] offset:512
    s_branch a_h
a_c:
    v_lshrrev_b32 v201, 5, v0
    v_and_b32 v200, 31, v0
    s_lshl2_add_u32 s60, s59, s3
    s_mul_i32 s60, s60, 2560
    v_mul_u32_u24 v1, 1280, v201
    v_lshl_add_u32 v2, v200, 3, s60
    v_add_u32 v1, v1, v2
    v_add_u32 v2, 122880, v1
    v_add_u32 v3, s62, v2
    s_waitcnt lgkmcnt(0)
    global_load_dwordx2 v[140:141], v1, s[4:5] offset:0
    global_load_dwordx2 v[142:143], v1, s[4:5] offset:256
    global_load_dwordx2 v[144:145], v1, s[4:5] offset:512
    global_load_dwordx2 v[146:147], v1, s[4:5] offset:768
    global_load_dwordx2 v[148:149], v1, s[4:5] offset:1024
    global_load_dwordx2 v[150:151], v2, s[4:5] offset:0
    global_load_dwordx2 v[152:153], v2, s[4:5] offset:256
    global_load_dwordx2 v[154:155], v2, s[4:5] offset:512
    global_load_dwordx2 v[156:157], v2, s[4:5] offset:768
    global_load_dwordx2 v[158:159], v2, s[4:5] offset:1024
    global_load_dwordx2 v[160:161], v3, s[4:5] offset:0
    global_load_dwordx2 v[162:163], v3, s[4:5] offset:256
    global_load_dwordx2 v[164:165], v3, s[4:5] offset:512
    global_load_dwordx2 v[166:167], v3, s[4:5] offset:768
    global_load_dwordx2 v[168:169], v3, s[4:5] offset:1024
    s_mul_i32 s60, s3, 2688
    s_add_u32 s60, s60, 8192
    v_mul_u32_u24 v252, 1344, v201
    v_lshl_add_u32 v252, v200, 3, v252
    v_add_u32 v60, s60, v252
    s_mov_b32 s75, 0x3f803f80
    v_lshrrev_b32 v252, 3, v0
    v_and_b32 v253, 7, v0
    s_lshl2_add_u32 s60, s48, s3
    s_mul_i32 s60, s60, 20480
    v_mul_u32_u24 v254, 1280, v252
    v_xor_b32 v4, v253, v250
    s_and_b32 s61, s3, 1
    s_lshl_b32 s61, s61, 2
    v_lshl_add_u32 v254, v4, 4, v254
    v_and_or_b32 v4, v252, 2, s61
    v_add_u32 v1, s60, v254
    v_xor_b32 v253, v253, v4
    s_lshl_b32 s60, s3, 6
    s_add_u32 s60, s60, s49
    s_mul_i32 s60, s60, 384
    v_mul_u32_u24 v252, 3072, v252
    v_xor_b32 v2, 64, v1
    v_lshl_add_u32 v252, v253, 4, v252
    v_add_u32 v2, 10240, v2
    v_add_u32 v3, s60, v252
    s_add_u32 s60, s50, s51
    s_mul_i32 s60, s60, 5
    s_and_b32 s61, s2, 7
    s_add_u32 s60, s60, s61
    s_mul_i32 s61, s60, 6554
    s_lshr_b32 s61, s61, 16
    s_mul_i32 s61, s61, 10
    s_sub_u32 s60, s60, s61
    s_mul_i32 s52, s60, 128
    s_mul_i32 s53, s60, 196608
    s_lshl_b32 s54, s3, 11
    s_mul_i32 s55, s3, 3072
    s_mov_b32 s6, 0x280000
    s_mov_b32 s7, 0x20000
    s_mov_b32 s10, 0x1e0000
    s_mov_b32 s11, 0x20000
    s_load_dwordx2 s[20:21], s[0:1], 88
    v_mov_b32 v228, 3584
    v_mov_b32 v229, 1
    s_mov_b32 s14, 0xd80000
    s_mov_b32 s15, 0x20000
    s_mov_b32 s22, 3072
    s_mov_b32 s23, 0x20000
    v_lshrrev_b32 v252, 1, v251
    v_xor_b32 v252, v252, v250
    v_lshlrev_b32 v252, 4, v252
    v_lshl_add_u32 v252, v251, 7, v252
    v_add_u32 v126, 139264, v252
    v_xor_b32 v127, 64, v126
    v_lshrrev_b32 v252, 2, v251
    v_and_b32 v254, 3, v0
    v_mul_u32_u24 v253, 3072, v250
    v_lshl_add_u32 v253, v252, 7, v253
    v_lshl_add_u32 v253, v254, 3, v253
    v_lshrrev_b32 v252, 1, v252
    v_and_b32 v254, 1, v250
    v_lshl_or_b32 v252, v254, 1, v252
    s_mul_i32 s60, s3, 3
    s_add_u32 s61, s60, 0
    s_lshr_b32 s66, s61, 2
    s_lshl_b32 s66, s66, 10
    s_add_u32 s66, s66, 65536
    s_and_b32 s61, s61, 3
    v_xor_b32 v254, s61, v252
    v_lshl_add_u32 v254, v254, 5, v253
    v_add_u32 v241, s66, v254
    s_add_u32 s61, s60, 1
    s_lshr_b32 s66, s61, 2
    s_lshl_b32 s66, s66, 10
    s_add_u32 s66, s66, 65536
    s_and_b32 s61, s61, 3
    v_xor_b32 v254, s61, v252
    v_lshl_add_u32 v254, v254, 5, v253
    v_add_u32 v242, s66, v254
    s_add_u32 s61, s60, 2
    s_lshr_b32 s66, s61, 2
    s_lshl_b32 s66, s66, 10
    s_add_u32 s66, s66, 65536
    s_and_b32 s61, s61, 3
    v_xor_b32 v254, s61, v252
    v_lshl_add_u32 v254, v254, 5, v253
    v_add_u32 v243, s66, v254
    v_mov_b32 v244, 0x3f803f80
    v_mov_b32 v245, 0x3f803f80
    v_mov_b32 v246, 0x3f803f80
    v_mov_b32 v247, 0x3f803f80
    v_add_u32 v249, 4096, v248
    s_mul_i32 s60, s49, 245760
    s_mul_i32 s61, s3, 61440
    s_add_u32 s60, s60, s61
    s_add_u32 s60, s60, 0x510000
    s_mul_i32 s63, s48, 196608
    s_mul_i32 s61, s3, 49152
    s_add_u32 s63, s63, s61
    s_add_u32 s63, s63, 0x700000
    s_mul_i32 s62, s50, 1
    s_mul_i32 s61, s51, 0
    s_add_u32 s62, s62, s61
    s_add_u32 s61, s62, 0
    s_and_b32 s61, s61, 3
    s_mul_i32 s64, s61, 15360
    s_add_u32 s40, s64, s60
    s_mul_i32 s64, s61, 12288
    s_add_u32 s44, s64, s63
    s_add_u32 s61, s62, 1
    s_and_b32 s61, s61, 3
    s_mul_i32 s64, s61, 15360
    s_add_u32 s41, s64, s60
    s_mul_i32 s64, s61, 12288
    s_add_u32 s45, s64, s63
    s_add_u32 s61, s62, 2
    s_and_b32 s61, s61, 3
    s_mul_i32 s64, s61, 15360
    s_add_u32 s42, s64, s60
    s_mul_i32 s64, s61, 12288
    s_add_u32 s46, s64, s63
    s_add_u32 s61, s62, 3
    s_and_b32 s61, s61, 3
    s_mul_i32 s64, s61, 15360
    s_add_u32 s43, s64, s60
    s_mul_i32 s64, s61, 12288
    s_add_u32 s47, s64, s63
    s_mul_i32 s67, s3, 10240
    s_add_u32 s67, s67, 34688
    s_mul_i32 s68, s3, 21504
    s_add_u32 s68, s68, 77824
    s_mul_i32 s65, s49, 384
    s_mul_i32 s61, s3, 96
    s_add_u32 s65, s65, s61
    v_lshlrev_b32 v254, 3, v250
    s_lshl_b32 s73, s48, 9
    s_add_u32 s73, s73, 0x8000
    v_lshlrev_b32 v230, 3, v251
    s_lshl3_add_u32 s60, s48, s49
    s_lshl2_add_u32 s60, s60, s3
    s_lshl_b32 s60, s60, 7
    s_add_u32 s74, s60, 0xd40000
    s_waitcnt vmcnt(14)
    v_dot2_f32_bf16 v54, v140, s75, 0
    v_dot2_f32_bf16 v55, v140, v140, 0
    v_dot2_f32_bf16 v58, v141, s75, 0
    v_dot2_f32_bf16 v59, v141, v141, 0
    s_waitcnt vmcnt(13)
    v_dot2_f32_bf16 v54, v142, s75, v54
    v_dot2_f32_bf16 v55, v142, v142, v55
    v_dot2_f32_bf16 v58, v143, s75, v58
    v_dot2_f32_bf16 v59, v143, v143, v59
    s_waitcnt vmcnt(12)
    v_dot2_f32_bf16 v54, v144, s75, v54
    v_dot2_f32_bf16 v55, v144, v144, v55
    v_dot2_f32_bf16 v58, v145, s75, v58
    v_dot2_f32_bf16 v59, v145, v145, v59
    s_waitcnt vmcnt(11)
    v_dot2_f32_bf16 v54, v146, s75, v54
    v_dot2_f32_bf16 v55, v146, v146, v55
    v_dot2_f32_bf16 v58, v147, s75, v58
    v_dot2_f32_bf16 v59, v147, v147, v59
    s_waitcnt vmcnt(10)
    v_dot2_f32_bf16 v54, v148, s75, v54
    v_dot2_f32_bf16 v55, v148, v148, v55
    v_dot2_f32_bf16 v58, v149, s75, v58
    v_dot2_f32_bf16 v59, v149, v149, v59
    v_lshlrev_b32 v170, 16, v140
    v_and_b32 v171, 0xffff0000, v140
    v_lshlrev_b32 v172, 16, v141
    v_add_f32 v54, v54, v58
    v_add_f32 v55, v55, v59
    v_and_b32 v173, 0xffff0000, v141
    v_lshlrev_b32 v174, 16, v142
    v_add_f32_dpp v54, v54, v54 row_ror:8 row_mask:0xf bank_mask:0xf
    v_add_f32_dpp v55, v55, v55 row_ror:8 row_mask:0xf bank_mask:0xf
    v_and_b32 v175, 0xffff0000, v142
    v_lshlrev_b32 v176, 16, v143
    v_add_f32_dpp v54, v54, v54 row_ror:4 row_mask:0xf bank_mask:0xf
    v_add_f32_dpp v55, v55, v55 row_ror:4 row_mask:0xf bank_mask:0xf
    v_and_b32 v177, 0xffff0000, v143
    v_lshlrev_b32 v178, 16, v144
    v_add_f32_dpp v54, v54, v54 row_ror:2 row_mask:0xf bank_mask:0xf
    v_add_f32_dpp v55, v55, v55 row_ror:2 row_mask:0xf bank_mask:0xf
    v_and_b32 v179, 0xffff0000, v144
    v_lshlrev_b32 v180, 16, v145
    v_add_f32_dpp v54, v54, v54 row_ror:1 row_mask:0xf bank_mask:0xf
    v_add_f32_dpp v55, v55, v55 row_ror:1 row_mask:0xf bank_mask:0xf
    v_mov_b32 v252, v54
    v_mov_b32 v253, v55
    v_and_b32 v181, 0xffff0000, v145
    v_lshlrev_b32 v182, 16, v146
    v_permlane16_swap_b32 v54, v252
    v_permlane16_swap_b32 v55, v253
    v_and_b32 v183, 0xffff0000, v146
    v_add_f32 v54, v54, v252
    v_add_f32 v55, v55, v253
    v_lshlrev_b32 v184, 16, v147
    v_mul_f32 v57, 0x3acccccd, v54
    v_mul_f32 v55, 0x3acccccd, v55
    v_and_b32 v185, 0xffff0000, v147
    v_cvt_pk_bf16_f32 v54, v57, v57
    v_fma_f32 v55, -v57, v57, v55
    v_lshlrev_b32 v186, 16, v148
    v_and_b32 v58, 0xffff0000, v54
    v_max_f32 v56, 0, v55
    v_and_b32 v187, 0xffff0000, v148
    v_lshlrev_b32 v188, 16, v149
    v_and_b32 v189, 0xffff0000, v149
    v_cvt_pk_bf16_f32 v55, v56, v56
    v_pk_add_f32 v[170:171], v[170:171], v[58:59] op_sel_hi:[1,0] neg_lo:[0,1] neg_hi:[0,1]
    v_pk_add_f32 v[172:173], v[172:173], v[58:59] op_sel_hi:[1,0] neg_lo:[0,1] neg_hi:[0,1]
    v_and_b32 v55, 0xffff0000, v55
    v_pk_add_f32 v[174:175], v[174:175], v[58:59] op_sel_hi:[1,0] neg_lo:[0,1] neg_hi:[0,1]
    v_pk_add_f32 v[176:177], v[176:177], v[58:59] op_sel_hi:[1,0] neg_lo:[0,1] neg_hi:[0,1]
    v_add_f32 v55, 0x3727c5ac, v55
    v_pk_add_f32 v[178:179], v[178:179], v[58:59] op_sel_hi:[1,0] neg_lo:[0,1] neg_hi:[0,1]
    v_pk_add_f32 v[180:181], v[180:181], v[58:59] op_sel_hi:[1,0] neg_lo:[0,1] neg_hi:[0,1]
    v_cvt_pk_bf16_f32 v55, v55, v55
    v_pk_add_f32 v[182:183], v[182:183], v[58:59] op_sel_hi:[1,0] neg_lo:[0,1] neg_hi:[0,1]
    v_pk_add_f32 v[184:185], v[184:185], v[58:59] op_sel_hi:[1,0] neg_lo:[0,1] neg_hi:[0,1]
    v_and_b32 v55, 0xffff0000, v55
    v_pk_add_f32 v[186:187], v[186:187], v[58:59] op_sel_hi:[1,0] neg_lo:[0,1] neg_hi:[0,1]
    v_pk_add_f32 v[188:189], v[188:189], v[58:59] op_sel_hi:[1,0] neg_lo:[0,1] neg_hi:[0,1]
    v_sqrt_f32 v55, v55
    v_cvt_pk_bf16_f32 v140, v170, v171
    v_cvt_pk_bf16_f32 v141, v172, v173
    v_cvt_pk_bf16_f32 v55, v55, v55
    v_cvt_pk_bf16_f32 v142, v174, v175
    v_cvt_pk_bf16_f32 v143, v176, v177
    v_and_b32 v55, 0xffff0000, v55
    v_cvt_pk_bf16_f32 v144, v178, v179
    v_cvt_pk_bf16_f32 v145, v180, v181
    v_rcp_f32 v55, v55
    v_cvt_pk_bf16_f32 v146, v182, v183
    v_cvt_pk_bf16_f32 v147, v184, v185
    v_cvt_pk_bf16_f32 v148, v186, v187
    v_cvt_pk_bf16_f32 v149, v188, v189
    v_mul_f32 v56, v56, v55
    v_lshlrev_b32 v170, 16, v140
    v_and_b32 v171, 0xffff0000, v140
    v_mul_f32 v56, v56, v55
    v_lshlrev_b32 v172, 16, v141
    v_and_b32 v173, 0xffff0000, v141
    v_cvt_pk_bf16_f32 v56, v56, v56
    v_lshlrev_b32 v174, 16, v142
    v_and_b32 v175, 0xffff0000, v142
    v_and_b32 v56, 0xffff0000, v56
    v_lshlrev_b32 v176, 16, v143
    v_and_b32 v177, 0xffff0000, v143
    v_add_f32 v56, 0x3727c5ac, v56
    v_lshlrev_b32 v178, 16, v144
    v_and_b32 v179, 0xffff0000, v144
    v_cvt_pk_bf16_f32 v56, v56, v56
    v_lshlrev_b32 v180, 16, v145
    v_and_b32 v181, 0xffff0000, v145
    v_and_b32 v56, 0xffff0000, v56
    v_lshlrev_b32 v182, 16, v146
    v_and_b32 v183, 0xffff0000, v146
    v_sqrt_f32 v56, v56
    v_lshlrev_b32 v184, 16, v147
    v_and_b32 v185, 0xffff0000, v147
    v_cvt_pk_bf16_f32 v56, v56, v56
    v_lshlrev_b32 v186, 16, v148
    v_and_b32 v187, 0xffff0000, v148
    v_and_b32 v56, 0xffff0000, v56
    v_lshlrev_b32 v188, 16, v149
    v_and_b32 v189, 0xffff0000, v149
    v_rcp_f32 v56, v56
    v_pk_mul_f32 v[170:171], v[54:55], v[170:171] op_sel:[1,0] op_sel_hi:[1,1]
    v_pk_mul_f32 v[172:173], v[54:55], v[172:173] op_sel:[1,0] op_sel_hi:[1,1]
    v_mul_f32 v56, v56, v55
    v_pk_mul_f32 v[174:175], v[54:55], v[174:175] op_sel:[1,0] op_sel_hi:[1,1]
    v_pk_mul_f32 v[176:177], v[54:55], v[176:177] op_sel:[1,0] op_sel_hi:[1,1]
    v_mul_f32_e64 v57, -v57, v56
    v_pk_mul_f32 v[178:179], v[54:55], v[178:179] op_sel:[1,0] op_sel_hi:[1,1]
    v_pk_mul_f32 v[180:181], v[54:55], v[180:181] op_sel:[1,0] op_sel_hi:[1,1]
    v_pk_mul_f32 v[182:183], v[54:55], v[182:183] op_sel:[1,0] op_sel_hi:[1,1]
    v_pk_mul_f32 v[184:185], v[54:55], v[184:185] op_sel:[1,0] op_sel_hi:[1,1]
    v_pk_mul_f32 v[186:187], v[54:55], v[186:187] op_sel:[1,0] op_sel_hi:[1,1]
    v_pk_mul_f32 v[188:189], v[54:55], v[188:189] op_sel:[1,0] op_sel_hi:[1,1]
    v_cvt_pk_bf16_f32 v140, v170, v171
    v_cvt_pk_bf16_f32 v141, v172, v173
    ds_write_b64 v60, v[140:141] offset:0
    v_cvt_pk_bf16_f32 v142, v174, v175
    v_cvt_pk_bf16_f32 v143, v176, v177
    ds_write_b64 v60, v[142:143] offset:256
    v_cvt_pk_bf16_f32 v144, v178, v179
    v_cvt_pk_bf16_f32 v145, v180, v181
    ds_write_b64 v60, v[144:145] offset:512
    v_cvt_pk_bf16_f32 v146, v182, v183
    v_cvt_pk_bf16_f32 v147, v184, v185
    ds_write_b64 v60, v[146:147] offset:768
    v_cvt_pk_bf16_f32 v148, v186, v187
    v_cvt_pk_bf16_f32 v149, v188, v189
    ds_write_b64 v60, v[148:149] offset:1024
    s_mov_b32 exec_lo, 1
    s_mov_b32 exec_hi, 1
    ds_write_b64 v60, v[56:57] offset:1280
    s_mov_b64 exec, -1
    s_waitcnt vmcnt(9)
    v_dot2_f32_bf16 v54, v150, s75, 0
    v_dot2_f32_bf16 v55, v150, v150, 0
    v_dot2_f32_bf16 v58, v151, s75, 0
    v_dot2_f32_bf16 v59, v151, v151, 0
    s_waitcnt vmcnt(8)
    v_dot2_f32_bf16 v54, v152, s75, v54
    v_dot2_f32_bf16 v55, v152, v152, v55
    v_dot2_f32_bf16 v58, v153, s75, v58
    v_dot2_f32_bf16 v59, v153, v153, v59
    s_waitcnt vmcnt(7)
    v_dot2_f32_bf16 v54, v154, s75, v54
    v_dot2_f32_bf16 v55, v154, v154, v55
    v_dot2_f32_bf16 v58, v155, s75, v58
    v_dot2_f32_bf16 v59, v155, v155, v59
    s_waitcnt vmcnt(6)
    v_dot2_f32_bf16 v54, v156, s75, v54
    v_dot2_f32_bf16 v55, v156, v156, v55
    v_dot2_f32_bf16 v58, v157, s75, v58
    v_dot2_f32_bf16 v59, v157, v157, v59
    s_waitcnt vmcnt(5)
    v_dot2_f32_bf16 v54, v158, s75, v54
    v_dot2_f32_bf16 v55, v158, v158, v55
    v_dot2_f32_bf16 v58, v159, s75, v58
    v_dot2_f32_bf16 v59, v159, v159, v59
    s_waitcnt lgkmcnt(0)
    s_barrier
    v_lshlrev_b32 v170, 16, v150
    v_and_b32 v171, 0xffff0000, v150
    v_lshlrev_b32 v172, 16, v151
    s_add_u32 m0, s54, 139264
    s_nop 0
    buffer_load_dwordx4 v1, s[4:7], s52 offen lds
    v_add_f32 v54, v54, v58
    v_add_f32 v55, v55, v59
    v_and_b32 v173, 0xffff0000, v151
    v_lshlrev_b32 v174, 16, v152
    v_add_f32_dpp v54, v54, v54 row_ror:8 row_mask:0xf bank_mask:0xf
    v_add_f32_dpp v55, v55, v55 row_ror:8 row_mask:0xf bank_mask:0xf
    v_and_b32 v175, 0xffff0000, v152
    v_lshlrev_b32 v176, 16, v153
    v_add_f32_dpp v54, v54, v54 row_ror:4 row_mask:0xf bank_mask:0xf
    v_add_f32_dpp v55, v55, v55 row_ror:4 row_mask:0xf bank_mask:0xf
    v_and_b32 v177, 0xffff0000, v153
    v_lshlrev_b32 v178, 16, v154
    v_add_f32_dpp v54, v54, v54 row_ror:2 row_mask:0xf bank_mask:0xf
    v_add_f32_dpp v55, v55, v55 row_ror:2 row_mask:0xf bank_mask:0xf
    v_and_b32 v179, 0xffff0000, v154
    v_lshlrev_b32 v180, 16, v155
    v_add_f32_dpp v54, v54, v54 row_ror:1 row_mask:0xf bank_mask:0xf
    v_add_f32_dpp v55, v55, v55 row_ror:1 row_mask:0xf bank_mask:0xf
    v_mov_b32 v252, v54
    v_mov_b32 v253, v55
    v_and_b32 v181, 0xffff0000, v155
    v_lshlrev_b32 v182, 16, v156
    v_permlane16_swap_b32 v54, v252
    v_permlane16_swap_b32 v55, v253
    v_and_b32 v183, 0xffff0000, v156
    v_add_f32 v54, v54, v252
    v_add_f32 v55, v55, v253
    v_lshlrev_b32 v184, 16, v157
    v_mul_f32 v57, 0x3acccccd, v54
    v_mul_f32 v55, 0x3acccccd, v55
    v_and_b32 v185, 0xffff0000, v157
    s_add_u32 m0, s54, 140288
    s_nop 0
    buffer_load_dwordx4 v2, s[4:7], s52 offen lds
    s_add_u32 s52, s52, 128
    s_cmp_eq_u32 s52, 1280
    s_cselect_b32 s52, 0, s52
    v_cvt_pk_bf16_f32 v54, v57, v57
    v_fma_f32 v55, -v57, v57, v55
    v_lshlrev_b32 v186, 16, v158
    v_and_b32 v58, 0xffff0000, v54
    v_max_f32 v56, 0, v55
    v_and_b32 v187, 0xffff0000, v158
    v_lshlrev_b32 v188, 16, v159
    v_and_b32 v189, 0xffff0000, v159
    v_cvt_pk_bf16_f32 v55, v56, v56
    v_pk_add_f32 v[170:171], v[170:171], v[58:59] op_sel_hi:[1,0] neg_lo:[0,1] neg_hi:[0,1]
    v_pk_add_f32 v[172:173], v[172:173], v[58:59] op_sel_hi:[1,0] neg_lo:[0,1] neg_hi:[0,1]
    v_and_b32 v55, 0xffff0000, v55
    v_pk_add_f32 v[174:175], v[174:175], v[58:59] op_sel_hi:[1,0] neg_lo:[0,1] neg_hi:[0,1]
    v_pk_add_f32 v[176:177], v[176:177], v[58:59] op_sel_hi:[1,0] neg_lo:[0,1] neg_hi:[0,1]
    v_add_f32 v55, 0x3727c5ac, v55
    v_pk_add_f32 v[178:179], v[178:179], v[58:59] op_sel_hi:[1,0] neg_lo:[0,1] neg_hi:[0,1]
    v_pk_add_f32 v[180:181], v[180:181], v[58:59] op_sel_hi:[1,0] neg_lo:[0,1] neg_hi:[0,1]
    v_cvt_pk_bf16_f32 v55, v55, v55
    v_pk_add_f32 v[182:183], v[182:183], v[58:59] op_sel_hi:[1,0] neg_lo:[0,1] neg_hi:[0,1]
    v_pk_add_f32 v[184:185], v[184:185], v[58:59] op_sel_hi:[1,0] neg_lo:[0,1] neg_hi:[0,1]
    v_and_b32 v55, 0xffff0000, v55
    v_pk_add_f32 v[186:187], v[186:187], v[58:59] op_sel_hi:[1,0] neg_lo:[0,1] neg_hi:[0,1]
    v_pk_add_f32 v[188:189], v[188:189], v[58:59] op_sel_hi:[1,0] neg_lo:[0,1] neg_hi:[0,1]
    v_sqrt_f32 v55, v55
    v_cvt_pk_bf16_f32 v150, v170, v171
    v_cvt_pk_bf16_f32 v151, v172, v173
    v_cvt_pk_bf16_f32 v55, v55, v55
    v_cvt_pk_bf16_f32 v152, v174, v175
    v_cvt_pk_bf16_f32 v153, v176, v177
    v_and_b32 v55, 0xffff0000, v55
    v_cvt_pk_bf16_f32 v154, v178, v179
    s_add_u32 m0, s55, 114688
    s_nop 0
    buffer_load_dwordx4 v3, s[8:11], s53 offen offset:0 lds
    v_cvt_pk_bf16_f32 v155, v180, v181
    v_rcp_f32 v55, v55
    v_cvt_pk_bf16_f32 v156, v182, v183
    v_cvt_pk_bf16_f32 v157, v184, v185
    v_cvt_pk_bf16_f32 v158, v186, v187
    v_cvt_pk_bf16_f32 v159, v188, v189
    v_mul_f32 v56, v56, v55
    v_lshlrev_b32 v170, 16, v150
    v_and_b32 v171, 0xffff0000, v150
    v_mul_f32 v56, v56, v55
    v_lshlrev_b32 v172, 16, v151
    v_and_b32 v173, 0xffff0000, v151
    v_cvt_pk_bf16_f32 v56, v56, v56
    v_lshlrev_b32 v174, 16, v152
    v_and_b32 v175, 0xffff0000, v152
    v_and_b32 v56, 0xffff0000, v56
    v_lshlrev_b32 v176, 16, v153
    v_and_b32 v177, 0xffff0000, v153
    v_add_f32 v56, 0x3727c5ac, v56
    v_lshlrev_b32 v178, 16, v154
    v_and_b32 v179, 0xffff0000, v154
    v_cvt_pk_bf16_f32 v56, v56, v56
    v_lshlrev_b32 v180, 16, v155
    v_and_b32 v181, 0xffff0000, v155
    v_and_b32 v56, 0xffff0000, v56
    v_lshlrev_b32 v182, 16, v156
    v_and_b32 v183, 0xffff0000, v156
    v_sqrt_f32 v56, v56
    v_lshlrev_b32 v184, 16, v157
    v_and_b32 v185, 0xffff0000, v157
    v_cvt_pk_bf16_f32 v56, v56, v56
    s_add_u32 m0, s55, 115584
    s_nop 0
    buffer_load_dwordx4 v3, s[8:11], s53 offen offset:128 lds
    v_lshlrev_b32 v186, 16, v158
    v_and_b32 v187, 0xffff0000, v158
    v_and_b32 v56, 0xffff0000, v56
    v_lshlrev_b32 v188, 16, v159
    v_and_b32 v189, 0xffff0000, v159
    v_rcp_f32 v56, v56
    v_pk_mul_f32 v[170:171], v[54:55], v[170:171] op_sel:[1,0] op_sel_hi:[1,1]
    v_pk_mul_f32 v[172:173], v[54:55], v[172:173] op_sel:[1,0] op_sel_hi:[1,1]
    v_mul_f32 v56, v56, v55
    v_pk_mul_f32 v[174:175], v[54:55], v[174:175] op_sel:[1,0] op_sel_hi:[1,1]
    v_pk_mul_f32 v[176:177], v[54:55], v[176:177] op_sel:[1,0] op_sel_hi:[1,1]
    v_mul_f32_e64 v57, -v57, v56
    v_pk_mul_f32 v[178:179], v[54:55], v[178:179] op_sel:[1,0] op_sel_hi:[1,1]
    v_pk_mul_f32 v[180:181], v[54:55], v[180:181] op_sel:[1,0] op_sel_hi:[1,1]
    v_pk_mul_f32 v[182:183], v[54:55], v[182:183] op_sel:[1,0] op_sel_hi:[1,1]
    v_pk_mul_f32 v[184:185], v[54:55], v[184:185] op_sel:[1,0] op_sel_hi:[1,1]
    v_pk_mul_f32 v[186:187], v[54:55], v[186:187] op_sel:[1,0] op_sel_hi:[1,1]
    v_pk_mul_f32 v[188:189], v[54:55], v[188:189] op_sel:[1,0] op_sel_hi:[1,1]
    v_cvt_pk_bf16_f32 v150, v170, v171
    v_cvt_pk_bf16_f32 v151, v172, v173
    ds_write_b64 v60, v[150:151] offset:10752
    v_cvt_pk_bf16_f32 v152, v174, v175
    v_cvt_pk_bf16_f32 v153, v176, v177
    ds_write_b64 v60, v[152:153] offset:11008
    v_cvt_pk_bf16_f32 v154, v178, v179
    v_cvt_pk_bf16_f32 v155, v180, v181
    ds_write_b64 v60, v[154:155] offset:11264
    v_cvt_pk_bf16_f32 v156, v182, v183
    v_cvt_pk_bf16_f32 v157, v184, v185
    ds_write_b64 v60, v[156:157] offset:11520
    v_cvt_pk_bf16_f32 v158, v186, v187
    v_cvt_pk_bf16_f32 v159, v188, v189
    ds_write_b64 v60, v[158:159] offset:11776
    s_mov_b32 exec_lo, 1
    s_mov_b32 exec_hi, 1
    ds_write_b64 v60, v[56:57] offset:12032
    s_mov_b64 exec, -1
    s_cmp_eq_u32 s71, 3
    s_cbranch_scc1 a_c2
    s_waitcnt lgkmcnt(0)
    s_barrier
    s_add_u32 m0, s55, 116480
    s_nop 0
    buffer_load_dwordx4 v3, s[8:11], s53 offen offset:256 lds
    s_add_u32 s53, s53, 98304
    s_add_u32 m0, s55, 126976
    s_nop 0
    buffer_load_dwordx4 v3, s[8:11], s53 offen offset:0 lds
    s_add_u32 m0, s55, 127872
    s_nop 0
    buffer_load_dwordx4 v3, s[8:11], s53 offen offset:128 lds
    s_add_u32 m0, s55, 128768
    s_nop 0
    buffer_load_dwordx4 v3, s[8:11], s53 offen offset:256 lds
    s_add_u32 s53, s53, 98304
    s_cmp_eq_u32 s53, 1966080
    s_cselect_b32 s53, 0, s53
    s_branch a_c3
a_c2:
    s_waitcnt vmcnt(8)
    v_dot2_f32_bf16 v54, v160, s75, 0
    v_dot2_f32_bf16 v55, v160, v160, 0
    v_dot2_f32_bf16 v58, v161, s75, 0
    v_dot2_f32_bf16 v59, v161, v161, 0
    s_waitcnt vmcnt(7)
    v_dot2_f32_bf16 v54, v162, s75, v54
    v_dot2_f32_bf16 v55, v162, v162, v55
    v_dot2_f32_bf16 v58, v163, s75, v58
    v_dot2_f32_bf16 v59, v163, v163, v59
    s_waitcnt vmcnt(6)
    v_dot2_f32_bf16 v54, v164, s75, v54
    v_dot2_f32_bf16 v55, v164, v164, v55
    v_dot2_f32_bf16 v58, v165, s75, v58
    v_dot2_f32_bf16 v59, v165, v165, v59
    s_waitcnt vmcnt(5)
    v_dot2_f32_bf16 v54, v166, s75, v54
    v_dot2_f32_bf16 v55, v166, v166, v55
    v_dot2_f32_bf16 v58, v167, s75, v58
    v_dot2_f32_bf16 v59, v167, v167, v59
    s_waitcnt vmcnt(4)
    v_dot2_f32_bf16 v54, v168, s75, v54
    v_dot2_f32_bf16 v55, v168, v168, v55
    v_dot2_f32_bf16 v58, v169, s75, v58
    v_dot2_f32_bf16 v59, v169, v169, v59
    s_waitcnt lgkmcnt(0)
    s_barrier
    v_lshlrev_b32 v170, 16, v160
    v_and_b32 v171, 0xffff0000, v160
    v_lshlrev_b32 v172, 16, v161
    s_add_u32 m0, s55, 116480
    s_nop 0
    buffer_load_dwordx4 v3, s[8:11], s53 offen offset:256 lds
    s_add_u32 s53, s53, 98304
    v_add_f32 v54, v54, v58
    v_add_f32 v55, v55, v59
    v_and_b32 v173, 0xffff0000, v161
    v_lshlrev_b32 v174, 16, v162
    v_add_f32_dpp v54, v54, v54 row_ror:8 row_mask:0xf bank_mask:0xf
    v_add_f32_dpp v55, v55, v55 row_ror:8 row_mask:0xf bank_mask:0xf
    v_and_b32 v175, 0xffff0000, v162
    v_lshlrev_b32 v176, 16, v163
    v_add_f32_dpp v54, v54, v54 row_ror:4 row_mask:0xf bank_mask:0xf
    v_add_f32_dpp v55, v55, v55 row_ror:4 row_mask:0xf bank_mask:0xf
    v_and_b32 v177, 0xffff0000, v163
    v_lshlrev_b32 v178, 16, v164
    v_add_f32_dpp v54, v54, v54 row_ror:2 row_mask:0xf bank_mask:0xf
    v_add_f32_dpp v55, v55, v55 row_ror:2 row_mask:0xf bank_mask:0xf
    v_and_b32 v179, 0xffff0000, v164
    v_lshlrev_b32 v180, 16, v165
    v_add_f32_dpp v54, v54, v54 row_ror:1 row_mask:0xf bank_mask:0xf
    v_add_f32_dpp v55, v55, v55 row_ror:1 row_mask:0xf bank_mask:0xf
    v_mov_b32 v252, v54
    v_mov_b32 v253, v55
    v_and_b32 v181, 0xffff0000, v165
    v_lshlrev_b32 v182, 16, v166
    v_permlane16_swap_b32 v54, v252
    v_permlane16_swap_b32 v55, v253
    v_and_b32 v183, 0xffff0000, v166
    v_add_f32 v54, v54, v252
    v_add_f32 v55, v55, v253
    v_lshlrev_b32 v184, 16, v167
    v_mul_f32 v57, 0x3acccccd, v54
    v_mul_f32 v55, 0x3acccccd, v55
    v_and_b32 v185, 0xffff0000, v167
    s_add_u32 m0, s55, 126976
    s_nop 0
    buffer_load_dwordx4 v3, s[8:11], s53 offen offset:0 lds
    v_cvt_pk_bf16_f32 v54, v57, v57
    v_fma_f32 v55, -v57, v57, v55
    v_lshlrev_b32 v186, 16, v168
    v_and_b32 v58, 0xffff0000, v54
    v_max_f32 v56, 0, v55
    v_and_b32 v187, 0xffff0000, v168
    v_lshlrev_b32 v188, 16, v169
    v_and_b32 v189, 0xffff0000, v169
    v_cvt_pk_bf16_f32 v55, v56, v56
    v_pk_add_f32 v[170:171], v[170:171], v[58:59] op_sel_hi:[1,0] neg_lo:[0,1] neg_hi:[0,1]
    v_pk_add_f32 v[172:173], v[172:173], v[58:59] op_sel_hi:[1,0] neg_lo:[0,1] neg_hi:[0,1]
    v_and_b32 v55, 0xffff0000, v55
    v_pk_add_f32 v[174:175], v[174:175], v[58:59] op_sel_hi:[1,0] neg_lo:[0,1] neg_hi:[0,1]
    v_pk_add_f32 v[176:177], v[176:177], v[58:59] op_sel_hi:[1,0] neg_lo:[0,1] neg_hi:[0,1]
    v_add_f32 v55, 0x3727c5ac, v55
    v_pk_add_f32 v[178:179], v[178:179], v[58:59] op_sel_hi:[1,0] neg_lo:[0,1] neg_hi:[0,1]
    v_pk_add_f32 v[180:181], v[180:181], v[58:59] op_sel_hi:[1,0] neg_lo:[0,1] neg_hi:[0,1]
    v_cvt_pk_bf16_f32 v55, v55, v55
    v_pk_add_f32 v[182:183], v[182:183], v[58:59] op_sel_hi:[1,0] neg_lo:[0,1] neg_hi:[0,1]
    v_pk_add_f32 v[184:185], v[184:185], v[58:59] op_sel_hi:[1,0] neg_lo:[0,1] neg_hi:[0,1]
    v_and_b32 v55, 0xffff0000, v55
    v_pk_add_f32 v[186:187], v[186:187], v[58:59] op_sel_hi:[1,0] neg_lo:[0,1] neg_hi:[0,1]
    v_pk_add_f32 v[188:189], v[188:189], v[58:59] op_sel_hi:[1,0] neg_lo:[0,1] neg_hi:[0,1]
    v_sqrt_f32 v55, v55
    v_cvt_pk_bf16_f32 v160, v170, v171
    v_cvt_pk_bf16_f32 v161, v172, v173
    v_cvt_pk_bf16_f32 v55, v55, v55
    v_cvt_pk_bf16_f32 v162, v174, v175
    v_cvt_pk_bf16_f32 v163, v176, v177
    v_and_b32 v55, 0xffff0000, v55
    v_cvt_pk_bf16_f32 v164, v178, v179
    s_add_u32 m0, s55, 127872
    s_nop 0
    buffer_load_dwordx4 v3, s[8:11], s53 offen offset:128 lds
    v_cvt_pk_bf16_f32 v165, v180, v181
    v_rcp_f32 v55, v55
    v_cvt_pk_bf16_f32 v166, v182, v183
    v_cvt_pk_bf16_f32 v167, v184, v185
    v_cvt_pk_bf16_f32 v168, v186, v187
    v_cvt_pk_bf16_f32 v169, v188, v189
    v_mul_f32 v56, v56, v55
    v_lshlrev_b32 v170, 16, v160
    v_and_b32 v171, 0xffff0000, v160
    v_mul_f32 v56, v56, v55
    v_lshlrev_b32 v172, 16, v161
    v_and_b32 v173, 0xffff0000, v161
    v_cvt_pk_bf16_f32 v56, v56, v56
    v_lshlrev_b32 v174, 16, v162
    v_and_b32 v175, 0xffff0000, v162
    v_and_b32 v56, 0xffff0000, v56
    v_lshlrev_b32 v176, 16, v163
    v_and_b32 v177, 0xffff0000, v163
    v_add_f32 v56, 0x3727c5ac, v56
    v_lshlrev_b32 v178, 16, v164
    v_and_b32 v179, 0xffff0000, v164
    v_cvt_pk_bf16_f32 v56, v56, v56
    v_lshlrev_b32 v180, 16, v165
    v_and_b32 v181, 0xffff0000, v165
    v_and_b32 v56, 0xffff0000, v56
    v_lshlrev_b32 v182, 16, v166
    v_and_b32 v183, 0xffff0000, v166
    v_sqrt_f32 v56, v56
    v_lshlrev_b32 v184, 16, v167
    v_and_b32 v185, 0xffff0000, v167
    v_cvt_pk_bf16_f32 v56, v56, v56
    s_add_u32 m0, s55, 128768
    s_nop 0
    buffer_load_dwordx4 v3, s[8:11], s53 offen offset:256 lds
    s_add_u32 s53, s53, 98304
    s_cmp_eq_u32 s53, 1966080
    s_cselect_b32 s53, 0, s53
    v_lshlrev_b32 v186, 16, v168
    v_and_b32 v187, 0xffff0000, v168
    v_and_b32 v56, 0xffff0000, v56
    v_lshlrev_b32 v188, 16, v169
    v_and_b32 v189, 0xffff0000, v169
    v_rcp_f32 v56, v56
    v_pk_mul_f32 v[170:171], v[54:55], v[170:171] op_sel:[1,0] op_sel_hi:[1,1]
    v_pk_mul_f32 v[172:173], v[54:55], v[172:173] op_sel:[1,0] op_sel_hi:[1,1]
    v_mul_f32 v56, v56, v55
    v_pk_mul_f32 v[174:175], v[54:55], v[174:175] op_sel:[1,0] op_sel_hi:[1,1]
    v_pk_mul_f32 v[176:177], v[54:55], v[176:177] op_sel:[1,0] op_sel_hi:[1,1]
    v_mul_f32_e64 v57, -v57, v56
    v_pk_mul_f32 v[178:179], v[54:55], v[178:179] op_sel:[1,0] op_sel_hi:[1,1]
    v_pk_mul_f32 v[180:181], v[54:55], v[180:181] op_sel:[1,0] op_sel_hi:[1,1]
    v_pk_mul_f32 v[182:183], v[54:55], v[182:183] op_sel:[1,0] op_sel_hi:[1,1]
    v_pk_mul_f32 v[184:185], v[54:55], v[184:185] op_sel:[1,0] op_sel_hi:[1,1]
    v_pk_mul_f32 v[186:187], v[54:55], v[186:187] op_sel:[1,0] op_sel_hi:[1,1]
    v_pk_mul_f32 v[188:189], v[54:55], v[188:189] op_sel:[1,0] op_sel_hi:[1,1]
    v_cvt_pk_bf16_f32 v160, v170, v171
    v_cvt_pk_bf16_f32 v161, v172, v173
    ds_write_b64 v60, v[160:161] offset:21504
    v_cvt_pk_bf16_f32 v162, v174, v175
    v_cvt_pk_bf16_f32 v163, v176, v177
    ds_write_b64 v60, v[162:163] offset:21760
    v_cvt_pk_bf16_f32 v164, v178, v179
    v_cvt_pk_bf16_f32 v165, v180, v181
    ds_write_b64 v60, v[164:165] offset:22016
    v_cvt_pk_bf16_f32 v166, v182, v183
    v_cvt_pk_bf16_f32 v167, v184, v185
    ds_write_b64 v60, v[166:167] offset:22272
    v_cvt_pk_bf16_f32 v168, v186, v187
    v_cvt_pk_bf16_f32 v169, v188, v189
    ds_write_b64 v60, v[168:169] offset:22528
    s_mov_b32 exec_lo, 1
    s_mov_b32 exec_hi, 1
    ds_write_b64 v60, v[56:57] offset:22784
    s_mov_b64 exec, -1
    s_waitcnt lgkmcnt(0)
    s_barrier
a_c3:
    s_branch c_g1
a_h:
    s_lshl2_add_u32 s73, s61, s3
    s_mul_i32 s73, s73, 48
    s_add_u32 s73, s73, s60
    s_mul_i32 s73, s73, 5120
    s_add_u32 s73, s73, 0x510000
    s_load_dwordx2 s[16:17], s[0:1], 112
    s_load_dwordx2 s[24:25], s[0:1], 104
    s_load_dwordx2 s[28:29], s[0:1], 120
    s_mov_b32 s6, 0x280000
    s_mov_b32 s7, 0x20000
    s_mov_b32 s14, 0xd80000
    s_mov_b32 s15, 0x20000
    s_mov_b32 s18, 0x280000
    s_mov_b32 s19, 0x20000
    s_mov_b32 s26, 0x500
    s_mov_b32 s27, 0x20000
    s_mov_b32 s30, 0x100
    s_mov_b32 s31, 0x20000
    s_mul_i32 s70, s3, 4096
    v_mov_b32 v227, 3584
    v_mov_b32 v245, 1
    s_movk_i32 s75, 128
    s_and_b32 s74, s2, 7
    s_lshl_b32 s74, s74, 8
    v_lshl_add_u32 v2, v0, 2, s74
    v_mov_b32 v100, 0
    v_mov_b32 v101, 0
    v_mov_b32 v102, 0
    v_mov_b32 v103, 0
    s_mov_b64 exec, 15
    ds_write_b128 v248, v[100:103] offset:3584
    s_mov_b64 exec, -1
    v_lshrrev_b32 v254, 2, v251
    v_and_b32 v253, 3, v0
    v_lshlrev_b32 v253, 3, v253
    v_mul_u32_u24 v61, 1344, v254
    v_lshrrev_b32 v62, 3, v0
    v_lshl_add_u32 v61, v250, 5, v61
    s_lshl_b32 s60, s3, 7
    s_add_u32 s60, s60, 8192
    v_mul_u32_u24 v62, 32640, v62
    v_add3_u32 v61, v61, v253, s60
    v_add_u32 v62, v62, v248
    v_mul_u32_u24 v60, 1344, v0
    v_lshlrev_b32 v63, 3, v0
    s_lshl_b32 s61, s59, 6
    s_lshl_b32 s64, s3, 18
    s_lshl1_add_u32 s64, s61, s64
    s_add_u32 s64, s64, 0x10000
    s_add_u32 s65, s64, 0x100000
    s_add_u32 s66, s64, 0x200000
    s_add_u32 s67, s61, 0x8000
    v_mul_u32_u24 v252, 5120, v250
    v_lshl_add_u32 v252, v254, 7, v252
    v_add_u32 v252, v252, v253
    v_add_u32 v249, 4096, v248
    s_mul_i32 s60, s3, 160
    s_add_u32 s60, s60, 0
    s_lshr_b32 s61, s60, 7
    s_mul_i32 s61, s61, 896
    s_add_u32 s60, s60, s61
    v_add_u32 v64, s60, v252
    s_mul_i32 s60, s3, 160
    s_add_u32 s60, s60, 32
    s_lshr_b32 s61, s60, 7
    s_mul_i32 s61, s61, 896
    s_add_u32 s60, s60, s61
    v_add_u32 v65, s60, v252
    s_mul_i32 s60, s3, 160
    s_add_u32 s60, s60, 64
    s_lshr_b32 s61, s60, 7
    s_mul_i32 s61, s61, 896
    s_add_u32 s60, s60, s61
    v_add_u32 v66, s60, v252
    s_mul_i32 s60, s3, 160
    s_add_u32 s60, s60, 96
    s_lshr_b32 s61, s60, 7
    s_mul_i32 s61, s61, 896
    s_add_u32 s60, s60, s61
    v_add_u32 v67, s60, v252
    s_mul_i32 s60, s3, 160
    s_add_u32 s60, s60, 128
    s_lshr_b32 s61, s60, 7
    s_mul_i32 s61, s61, 896
    s_add_u32 s60, s60, s61
    v_add_u32 v68, s60, v252
    s_lshl2_add_u32 s60, s72, s3
    s_mul_i32 s60, s60, 768
    s_add_u32 s60, s60, 0xd40000
    v_lshrrev_b32 v252, 1, v0
    v_mul_u32_u24 v252, 96, v252
    v_add_u32 v252, v252, v248
    s_mov_b64 exec, 0xfff
    buffer_store_dwordx4 v[100:103], v252, s[12:15], s60 offen sc1
    s_mov_b64 exec, -1
    s_mov_b32 s69, 0
    s_waitcnt vmcnt(1) lgkmcnt(0)
a_mv:
    s_barrier
    ds_read_b64_tr_b16 v[4:5], v61 offset:0
    ds_read_b64_tr_b16 v[6:7], v61 offset:5376
    ds_read_b64_tr_b16 v[8:9], v61 offset:512
    ds_read_b64_tr_b16 v[10:11], v61 offset:5888
    s_cmp_ge_u32 s3, 2
    s_cbranch_scc1 a_m3
    ds_read_b64_tr_b16 v[12:13], v61 offset:1024
    ds_read_b64_tr_b16 v[14:15], v61 offset:6400
    s_waitcnt lgkmcnt(0)
    buffer_store_dwordx4 v[12:15], v62, s[12:15], s66 offen sc1
a_m3:
    s_cmp_lg_u32 s3, 3
    s_cbranch_scc1 a_m4
    s_mov_b64 exec, 0xff
    ds_read_b64 v[12:13], v60 offset:9472
    s_waitcnt lgkmcnt(0)
    buffer_store_dwordx2 v[12:13], v63, s[12:15], s67 offen sc1
    s_mov_b64 exec, -1
a_m4:
    s_waitcnt lgkmcnt(2)
    buffer_store_dwordx4 v[4:7], v62, s[12:15], s64 offen sc1
    s_waitcnt lgkmcnt(0)
    buffer_store_dwordx4 v[8:11], v62, s[12:15], s65 offen sc1
    s_cmp_eq_u32 s69, 2
    s_cbranch_scc1 a_m6
    s_cmp_eq_u32 s69, 1
    s_cbranch_scc1 a_m5
    ds_read_b64_tr_b16 v[72:73], v64 offset:40960
    ds_read_b64_tr_b16 v[74:75], v64 offset:41472
    ds_read_b64_tr_b16 v[76:77], v65 offset:40960
    ds_read_b64_tr_b16 v[78:79], v65 offset:41472
    ds_read_b64_tr_b16 v[80:81], v66 offset:40960
    ds_read_b64_tr_b16 v[82:83], v66 offset:41472
    ds_read_b64_tr_b16 v[84:85], v67 offset:40960
    ds_read_b64_tr_b16 v[86:87], v67 offset:41472
    ds_read_b64_tr_b16 v[88:89], v68 offset:40960
    ds_read_b64_tr_b16 v[90:91], v68 offset:41472
    s_waitcnt lgkmcnt(0)
    buffer_store_dwordx4 v[72:75], v248, s[12:15], s73 offen offset:0 sc1
    buffer_store_dwordx4 v[76:79], v248, s[12:15], s73 offen offset:1024 sc1
    buffer_store_dwordx4 v[80:83], v248, s[12:15], s73 offen offset:2048 sc1
    buffer_store_dwordx4 v[84:87], v248, s[12:15], s73 offen offset:3072 sc1
    buffer_store_dwordx4 v[88:91], v249, s[12:15], s73 offen offset:0 sc1
    s_branch a_m6
a_m5:
a_m6:
    v_add_u32 v60, 10752, v60
    v_add_u32 v61, 10752, v61
    s_add_u32 s64, s64, 1536
    s_add_u32 s65, s65, 1536
    s_add_u32 s66, s66, 1536
    s_add_u32 s67, s67, 768
    s_add_u32 s69, s69, 1
    s_cmp_lt_u32 s69, s71
    s_cbranch_scc1 a_mv
    v_mov_b32 v255, 0
    buffer_load_dword v254, off, s[28:31], 0 sc1
    s_mov_b32 s69, 0
    s_mov_b32 s68, 0
a_bl:
    s_cmp_ge_u32 s69, 8
    s_cbranch_scc1 a_b1
    s_getreg_b32 s60, hwreg(HW_REG_IB_STS)
    s_and_b32 s60, s60, 0xc000000f
    s_cmp_lg_u32 s60, 0
    s_cbranch_scc1 a_b2
a_b1:
    s_waitcnt vmcnt(0)
    s_cmp_lg_u32 s68, 0
    s_cbranch_scc1 a_b3
    s_mov_b32 s68, 1
    s_mov_b64 exec, 1
    ds_add_rtn_u32 v253, v227, v245 offset:36
    s_waitcnt lgkmcnt(0)
    v_readfirstlane_b32 s60, v253
    s_mov_b64 exec, -1
    s_cmp_eq_u32 s60, 3
    s_cbranch_scc0 a_na
    s_mov_b64 exec, 1
    s_mov_b32 s76, 0
    s_branch RDAc_29
RDA_27:
    s_sleep 4
    buffer_load_dword v254, off, s[28:31], 0 sc1
    s_waitcnt vmcnt(0)
RDAc_29:
    v_cmp_ne_u32 vcc, 1, v254
    s_add_u32 s76, s76, 1
    s_cmp_gt_u32 s76, 200000
    s_cbranch_scc1 RDAx_28
    s_cbranch_vccnz RDA_27
RDAx_28:
    s_mov_b64 exec, -1
    v_mov_b32 v255, 1
    s_mov_b64 exec, 1
    buffer_atomic_add v255, off, s[12:15], s74 sc0 sc1
    s_mov_b64 exec, -1
a_na:
    s_branch a_b2
a_b3:
    v_readfirstlane_b32 s60, v255
    s_cmp_lg_u32 s60, 11
    s_cbranch_scc1 a_b2
    v_lshlrev_b32 v255, 8, v0
    s_and_b32 s60, s2, 7
    s_mov_b64 exec, 0xff
    buffer_store_byte v245, v255, s[12:15], s60 offen offset:2048 sc1
    s_mov_b64 exec, -1
a_b2:
    s_barrier
    s_add_u32 s69, s69, 1
    s_cmp_lt_u32 s69, 10
    s_cbranch_scc1 a_bl
    s_barrier
    s_mul_i32 s60, s49, 245760
    s_mul_i32 s61, s3, 61440
    s_add_u32 s60, s60, s61
    s_add_u32 s60, s60, 0x510000
    s_mul_i32 s63, s48, 196608
    s_mul_i32 s61, s3, 49152
    s_add_u32 s63, s63, s61
    s_add_u32 s63, s63, 0x700000
    s_mul_i32 s62, s50, 1
    s_mul_i32 s61, s51, 0
    s_add_u32 s62, s62, s61
    s_add_u32 s61, s62, 0
    s_and_b32 s61, s61, 3
    s_mul_i32 s64, s61, 15360
    s_add_u32 s40, s64, s60
    s_add_u32 s61, s62, 1
    s_and_b32 s61, s61, 3
    s_mul_i32 s64, s61, 15360
    s_add_u32 s41, s64, s60
    s_add_u32 s61, s62, 2
    s_and_b32 s61, s61, 3
    s_mul_i32 s64, s61, 15360
    s_add_u32 s42, s64, s60
    s_add_u32 s61, s62, 3
    s_and_b32 s61, s61, 3
    s_mul_i32 s64, s61, 15360
    s_add_u32 s43, s64, s60
    s_mul_i32 s67, s3, 10240
    s_add_u32 s67, s67, 34688
    s_mul_i32 s68, s3, 21504
    s_add_u32 s68, s68, 77824
    s_barrier
    s_barrier
    s_barrier
    s_cmp_lg_u32 s3, 0
    s_cbranch_scc1 w0_30
    s_movk_i32 s75, 2048
    s_mov_b64 exec, 3
    buffer_load_dword v255, v2, s[12:15], s75 offen sc1
    s_mov_b64 exec, -1
w0_30:
    s_barrier
    s_cmp_lg_u32 s3, 0
    s_cbranch_scc1 w0_31
    s_mov_b64 exec, 3
    s_mov_b32 s76, 0
    s_branch PREc_34
PRE_32:
    s_sleep 4
    buffer_load_dword v255, v2, s[12:15], s75 offen sc1
    s_waitcnt vmcnt(0)
PREc_34:
    s_waitcnt vmcnt(0)
    v_cmp_ne_u32 vcc, 0x01010101, v255
    s_add_u32 s76, s76, 1
    s_cmp_gt_u32 s76, 200000
    s_cbranch_scc1 PREx_33
    s_cbranch_vccnz PRE_32
PREx_33:
    s_mov_b64 exec, -1
w0_31:
    s_barrier
    s_add_u32 s69, s42, 0
    s_add_u32 m0, s67, 0
    s_nop 0
    buffer_load_dwordx4 v248, s[12:15], s69 offen sc1 lds
    s_barrier
    buffer_load_dwordx4 v248, s[12:15], s69 offen offset:1024 sc1 lds
    buffer_load_dwordx4 v248, s[12:15], s69 offen offset:2048 sc1 lds
    buffer_load_dwordx4 v248, s[12:15], s69 offen offset:3072 sc1 lds
    s_add_u32 m0, s67, 4096
    s_nop 0
    buffer_load_dwordx4 v249, s[12:15], s69 offen sc1 lds
    s_barrier
    s_add_u32 s69, s42, 5120
    s_add_u32 m0, s67, 5120
    s_nop 0
    buffer_load_dwordx4 v248, s[12:15], s69 offen sc1 lds
    buffer_load_dwordx4 v248, s[12:15], s69 offen offset:1024 sc1 lds
    buffer_load_dwordx4 v248, s[12:15], s69 offen offset:2048 sc1 lds
    buffer_load_dwordx4 v248, s[12:15], s69 offen offset:3072 sc1 lds
    s_barrier
    s_add_u32 m0, s67, 9216
    s_nop 0
    buffer_load_dwordx4 v249, s[12:15], s69 offen sc1 lds
    s_barrier
    s_barrier
    s_add_u32 s69, s42, 10240
    s_add_u32 m0, s68, 0
    s_nop 0
    buffer_load_dwordx4 v248, s[12:15], s69 offen sc1 lds
    s_waitcnt vmcnt(6)
    buffer_load_dwordx4 v248, s[12:15], s69 offen offset:1024 sc1 lds
    s_waitcnt vmcnt(6)
    buffer_load_dwordx4 v248, s[12:15], s69 offen offset:2048 sc1 lds
    s_waitcnt vmcnt(6)
    buffer_load_dwordx4 v248, s[12:15], s69 offen offset:3072 sc1 lds
    s_waitcnt vmcnt(6)
    s_add_u32 m0, s68, 4096
    s_nop 0
    buffer_load_dwordx4 v249, s[12:15], s69 offen sc1 lds
    s_waitcnt vmcnt(6)
    s_add_u32 s69, s43, 0
    s_add_u32 m0, s68, 5120
    s_nop 0
    buffer_load_dwordx4 v248, s[12:15], s69 offen sc1 lds
    s_waitcnt vmcnt(6)
    buffer_load_dwordx4 v248, s[12:15], s69 offen offset:1024 sc1 lds
    s_waitcnt vmcnt(6)
    buffer_load_dwordx4 v248, s[12:15], s69 offen offset:2048 sc1 lds
    s_waitcnt vmcnt(6)
    buffer_load_dwordx4 v248, s[12:15], s69 offen offset:3072 sc1 lds
    s_waitcnt vmcnt(6)
    s_add_u32 m0, s68, 9216
    s_nop 0
    buffer_load_dwordx4 v249, s[12:15], s69 offen sc1 lds
    s_waitcnt vmcnt(6)
    s_add_u32 s69, s43, 5120
    s_add_u32 m0, s68, 10240
    s_nop 0
    buffer_load_dwordx4 v248, s[12:15], s69 offen sc1 lds
    s_waitcnt vmcnt(6)
    buffer_load_dwordx4 v248, s[12:15], s69 offen offset:1024 sc1 lds
    s_waitcnt vmcnt(6)
    buffer_load_dwordx4 v248, s[12:15], s69 offen offset:2048 sc1 lds
    s_waitcnt vmcnt(6)
    buffer_load_dwordx4 v248, s[12:15], s69 offen offset:3072 sc1 lds
    s_waitcnt vmcnt(6)
    s_add_u32 m0, s68, 14336
    s_nop 0
    buffer_load_dwordx4 v249, s[12:15], s69 offen sc1 lds
    s_waitcnt vmcnt(6)
    s_waitcnt vmcnt(0)
    s_mov_b64 exec, 1
    ds_add_u32 v227, v245 offset:12
    s_mov_b64 exec, -1
    s_mov_b32 s76, 0
    s_branch lw_35f
lw_35:
    s_sleep 1
    s_add_u32 s76, s76, 1
    s_cmp_gt_u32 s76, 1600000
    s_cbranch_scc1 lx_36
lw_35f:
    ds_read_b32 v253, v227 offset:0
    s_waitcnt lgkmcnt(0)
    v_readfirstlane_b32 s60, v253
    s_cmp_lt_u32 s60, 4
    s_cbranch_scc1 lw_35
lx_36:
    v_min_u32 v220, 59, v0
    s_mul_i32 s36, s3, 6
    v_mul_u32_u24 v221, 6554, v220
    s_lshl_b32 s61, s48, 6
    v_lshrrev_b32 v221, 16, v221
    s_mul_i32 s61, s61, 1280
    v_mul_u32_u24 v222, 10, v221
    s_mul_i32 s62, s49, 160
    v_sub_u32 v220, v220, v222
    s_add_u32 s61, s61, s62
    v_lshlrev_b32 v239, 4, v220
    v_mul_u32_u24 v222, 1280, v221
    v_add3_u32 v238, v222, v239, s61
    s_mul_i32 s32, s36, 1280
    s_add_u32 s33, s32, 30720
    s_mul_i32 s34, s3, 5120
    s_add_u32 s34, s34, 61440
    s_mov_b32 exec_hi, 0x0fffffff
    buffer_load_dwordx4 v[180:183], v238, s[4:7], s32 offen
    s_mov_b32 exec_hi, -1
    s_mov_b32 exec_hi, 0x0fffffff
    buffer_load_dwordx4 v[184:187], v238, s[4:7], s33 offen
    s_mov_b32 exec_hi, -1
    s_mov_b32 exec_hi, 0xff
    buffer_load_dwordx4 v[188:191], v238, s[4:7], s34 offen
    s_mov_b32 exec_hi, -1
    buffer_load_dwordx4 v[192:195], v239, s[24:27], s62 offen
    s_mul_i32 s61, s36, 176
    s_add_u32 s61, s61, 16384
    v_mul_u32_u24 v222, 176, v221
    v_add3_u32 v244, v222, v239, s61
    s_mul_i32 s61, s36, 336
    s_add_u32 s61, s61, 77824
    v_mul_u32_u24 v222, 336, v221
    v_lshl_add_u32 v222, v220, 5, v222
    v_add_u32 v240, s61, v222
    v_add_u32 v241, 43008, v240
    s_mul_i32 s61, s3, 672
    v_subrev_u32 v242, s61, v240
    v_subrev_u32 v243, s61, v241
    s_mul_i32 s61, s3, 352
    v_subrev_u32 v224, s61, v244
    v_lshrrev_b32 v220, 3, v0
    v_mul_u32_u24 v220, 3968, v220
    v_add_u32 v229, v220, v248
    v_add_u32 v230, 0x8000, v229
    v_add_u32 v231, 0x10000, v229
    v_lshrrev_b32 v220, 2, v251
    v_and_b32 v221, 2, v0
    v_lshlrev_b32 v220, 7, v220
    v_and_b32 v222, 1, v0
    v_lshl_add_u32 v220, v221, 5, v220
    v_lshl_add_u32 v220, v250, 4, v220
    v_lshl_add_u32 v220, v222, 3, v220
    v_add_u32 v225, s70, v220
    s_mul_i32 s61, s3, 40
    s_add_u32 s61, s61, 16384
    v_mul_u32_u24 v220, 176, v0
    v_add_u32 v226, s61, v220
    s_lshl2_add_u32 s38, s49, s3
    s_mul_i32 s37, s38, 81920
    s_lshl_b32 s61, s48, 7
    s_add_u32 s37, s37, s61
    s_add_u32 s37, s37, 0x290000
    s_lshl_b32 s38, s38, 12
    s_add_u32 s38, s38, s61
    s_add_u32 s38, s38, 0xd60000
    s_waitcnt vmcnt(0)
    v_lshlrev_b32 v220, 16, v192
    v_and_b32 v221, 0xffff0000, v192
    v_lshlrev_b32 v196, 16, v180
    v_and_b32 v197, 0xffff0000, v180
    v_add_f32 v196, v196, v220
    v_add_f32 v197, v197, v221
    v_lshlrev_b32 v204, 16, v184
    v_and_b32 v205, 0xffff0000, v184
    v_add_f32 v204, v204, v220
    v_add_f32 v205, v205, v221
    v_lshlrev_b32 v212, 16, v188
    v_and_b32 v213, 0xffff0000, v188
    v_add_f32 v212, v212, v220
    v_add_f32 v213, v213, v221
    v_lshlrev_b32 v220, 16, v193
    v_and_b32 v221, 0xffff0000, v193
    v_lshlrev_b32 v198, 16, v181
    v_and_b32 v199, 0xffff0000, v181
    v_add_f32 v198, v198, v220
    v_add_f32 v199, v199, v221
    v_lshlrev_b32 v206, 16, v185
    v_and_b32 v207, 0xffff0000, v185
    v_add_f32 v206, v206, v220
    v_add_f32 v207, v207, v221
    v_lshlrev_b32 v214, 16, v189
    v_and_b32 v215, 0xffff0000, v189
    v_add_f32 v214, v214, v220
    v_add_f32 v215, v215, v221
    v_lshlrev_b32 v220, 16, v194
    v_and_b32 v221, 0xffff0000, v194
    v_lshlrev_b32 v200, 16, v182
    v_and_b32 v201, 0xffff0000, v182
    v_add_f32 v200, v200, v220
    v_add_f32 v201, v201, v221
    v_lshlrev_b32 v208, 16, v186
    v_and_b32 v209, 0xffff0000, v186
    v_add_f32 v208, v208, v220
    v_add_f32 v209, v209, v221
    v_lshlrev_b32 v216, 16, v190
    v_and_b32 v217, 0xffff0000, v190
    v_add_f32 v216, v216, v220
    v_add_f32 v217, v217, v221
    v_lshlrev_b32 v220, 16, v195
    v_and_b32 v221, 0xffff0000, v195
    v_lshlrev_b32 v202, 16, v183
    v_and_b32 v203, 0xffff0000, v183
    v_add_f32 v202, v202, v220
    v_add_f32 v203, v203, v221
    v_lshlrev_b32 v210, 16, v187
    v_and_b32 v211, 0xffff0000, v187
    v_add_f32 v210, v210, v220
    v_add_f32 v211, v211, v221
    v_lshlrev_b32 v218, 16, v191
    v_and_b32 v219, 0xffff0000, v191
    v_add_f32 v218, v218, v220
    v_add_f32 v219, v219, v221
    s_branch h_fin
.p2align 6
role_c:
    v_lshrrev_b32 v252, 3, v0
    v_and_b32 v253, 7, v0
    s_lshl2_add_u32 s60, s48, s3
    s_mul_i32 s60, s60, 20480
    v_mul_u32_u24 v254, 1280, v252
    v_xor_b32 v4, v253, v250
    s_and_b32 s61, s3, 1
    s_lshl_b32 s61, s61, 2
    v_lshl_add_u32 v254, v4, 4, v254
    v_and_or_b32 v4, v252, 2, s61
    v_add_u32 v1, s60, v254
    v_xor_b32 v253, v253, v4
    s_lshl_b32 s60, s3, 6
    s_add_u32 s60, s60, s49
    s_mul_i32 s60, s60, 384
    v_mul_u32_u24 v252, 3072, v252
    v_xor_b32 v2, 64, v1
    v_lshl_add_u32 v252, v253, 4, v252
    v_add_u32 v2, 10240, v2
    v_add_u32 v3, s60, v252
    s_add_u32 s60, s50, s51
    s_mul_i32 s60, s60, 5
    s_and_b32 s61, s2, 7
    s_add_u32 s60, s60, s61
    s_mul_i32 s61, s60, 6554
    s_lshr_b32 s61, s61, 16
    s_mul_i32 s61, s61, 10
    s_sub_u32 s60, s60, s61
    s_mul_i32 s52, s60, 128
    s_mul_i32 s53, s60, 196608
    s_lshl_b32 s54, s3, 11
    s_mul_i32 s55, s3, 3072
    s_mov_b32 s6, 0x280000
    s_mov_b32 s7, 0x20000
    s_mov_b32 s10, 0x1e0000
    s_mov_b32 s11, 0x20000
    s_cmp_ge_u32 s2, 160
    s_cbranch_scc1 c_nob
    s_barrier
c_nob:
    s_add_u32 m0, s54, 139264
    s_waitcnt lgkmcnt(0)
    buffer_load_dwordx4 v1, s[4:7], s52 offen lds
    s_add_u32 m0, s54, 140288
    s_nop 0
    buffer_load_dwordx4 v2, s[4:7], s52 offen lds
    s_add_u32 s52, s52, 128
    s_cmp_eq_u32 s52, 1280
    s_cselect_b32 s52, 0, s52
    s_add_u32 m0, s55, 114688
    s_nop 0
    buffer_load_dwordx4 v3, s[8:11], s53 offen offset:0 lds
    s_add_u32 m0, s55, 115584
    s_nop 0
    buffer_load_dwordx4 v3, s[8:11], s53 offen offset:128 lds
    s_add_u32 m0, s55, 116480
    s_nop 0
    buffer_load_dwordx4 v3, s[8:11], s53 offen offset:256 lds
    s_add_u32 s53, s53, 98304
    s_load_dwordx2 s[20:21], s[0:1], 88
    v_mov_b32 v228, 3584
    v_mov_b32 v229, 1
    s_mov_b32 s14, 0xd80000
    s_mov_b32 s15, 0x20000
    s_mov_b32 s22, 3072
    s_mov_b32 s23, 0x20000
    v_lshrrev_b32 v252, 1, v251
    v_xor_b32 v252, v252, v250
    v_lshlrev_b32 v252, 4, v252
    v_lshl_add_u32 v252, v251, 7, v252
    v_add_u32 v126, 139264, v252
    v_xor_b32 v127, 64, v126
    v_lshrrev_b32 v252, 2, v251
    v_and_b32 v254, 3, v0
    v_mul_u32_u24 v253, 3072, v250
    v_lshl_add_u32 v253, v252, 7, v253
    v_lshl_add_u32 v253, v254, 3, v253
    v_lshrrev_b32 v252, 1, v252
    v_and_b32 v254, 1, v250
    v_lshl_or_b32 v252, v254, 1, v252
    s_mul_i32 s60, s3, 3
    s_add_u32 s61, s60, 0
    s_lshr_b32 s66, s61, 2
    s_lshl_b32 s66, s66, 10
    s_add_u32 s66, s66, 65536
    s_and_b32 s61, s61, 3
    v_xor_b32 v254, s61, v252
    v_lshl_add_u32 v254, v254, 5, v253
    v_add_u32 v241, s66, v254
    s_add_u32 s61, s60, 1
    s_lshr_b32 s66, s61, 2
    s_lshl_b32 s66, s66, 10
    s_add_u32 s66, s66, 65536
    s_add_u32 m0, s55, 126976
    s_nop 0
    buffer_load_dwordx4 v3, s[8:11], s53 offen offset:0 lds
    s_and_b32 s61, s61, 3
    v_xor_b32 v254, s61, v252
    v_lshl_add_u32 v254, v254, 5, v253
    v_add_u32 v242, s66, v254
    s_add_u32 s61, s60, 2
    s_lshr_b32 s66, s61, 2
    s_lshl_b32 s66, s66, 10
    s_add_u32 s66, s66, 65536
    s_and_b32 s61, s61, 3
    v_xor_b32 v254, s61, v252
    v_lshl_add_u32 v254, v254, 5, v253
    v_add_u32 v243, s66, v254
    v_mov_b32 v244, 0x3f803f80
    v_mov_b32 v245, 0x3f803f80
    v_mov_b32 v246, 0x3f803f80
    v_mov_b32 v247, 0x3f803f80
    v_add_u32 v249, 4096, v248
    s_mul_i32 s60, s49, 245760
    s_mul_i32 s61, s3, 61440
    s_add_u32 s60, s60, s61
    s_add_u32 s60, s60, 0x510000
    s_mul_i32 s63, s48, 196608
    s_mul_i32 s61, s3, 49152
    s_add_u32 s63, s63, s61
    s_add_u32 s63, s63, 0x700000
    s_mul_i32 s62, s50, 1
    s_mul_i32 s61, s51, 0
    s_add_u32 s62, s62, s61
    s_add_u32 s61, s62, 0
    s_and_b32 s61, s61, 3
    s_mul_i32 s64, s61, 15360
    s_add_u32 s40, s64, s60
    s_mul_i32 s64, s61, 12288
    s_add_u32 s44, s64, s63
    s_add_u32 m0, s55, 127872
    s_nop 0
    buffer_load_dwordx4 v3, s[8:11], s53 offen offset:128 lds
    s_add_u32 s61, s62, 1
    s_and_b32 s61, s61, 3
    s_mul_i32 s64, s61, 15360
    s_add_u32 s41, s64, s60
    s_mul_i32 s64, s61, 12288
    s_add_u32 s45, s64, s63
    s_add_u32 s61, s62, 2
    s_and_b32 s61, s61, 3
    s_mul_i32 s64, s61, 15360
    s_add_u32 s42, s64, s60
    s_mul_i32 s64, s61, 12288
    s_add_u32 s46, s64, s63
    s_add_u32 s61, s62, 3
    s_and_b32 s61, s61, 3
    s_mul_i32 s64, s61, 15360
    s_add_u32 s43, s64, s60
    s_mul_i32 s64, s61, 12288
    s_add_u32 s47, s64, s63
    s_mul_i32 s67, s3, 10240
    s_add_u32 s67, s67, 34688
    s_mul_i32 s68, s3, 21504
    s_add_u32 s68, s68, 77824
    s_mul_i32 s65, s49, 384
    s_mul_i32 s61, s3, 96
    s_add_u32 s65, s65, s61
    v_lshlrev_b32 v254, 3, v250
    s_lshl_b32 s73, s48, 9
    s_add_u32 s73, s73, 0x8000
    v_lshlrev_b32 v230, 3, v251
    s_lshl3_add_u32 s60, s48, s49
    s_lshl2_add_u32 s60, s60, s3
    s_lshl_b32 s60, s60, 7
    s_add_u32 s74, s60, 0xd40000
    s_add_u32 m0, s55, 128768
    s_nop 0
    buffer_load_dwordx4 v3, s[8:11], s53 offen offset:256 lds
    s_add_u32 s53, s53, 98304
    s_cmp_eq_u32 s53, 1966080
    s_cselect_b32 s53, 0, s53
c_g1:
    s_waitcnt vmcnt(3) lgkmcnt(0)
    s_barrier
    ds_read_b64_tr_b16 v[64:65], v241 offset:49152
    ds_read_b64_tr_b16 v[66:67], v241 offset:49664
    ds_read_b64_tr_b16 v[68:69], v242 offset:49152
    ds_read_b64_tr_b16 v[70:71], v242 offset:49664
    ds_read_b64_tr_b16 v[72:73], v243 offset:49152
    ds_read_b64_tr_b16 v[74:75], v243 offset:49664
    ds_read_b128 v[76:79], v126 offset:0
    ds_read_b128 v[80:83], v126 offset:2048
    ds_read_b128 v[84:87], v126 offset:4096
    ds_read_b128 v[88:91], v126 offset:6144
    s_add_u32 m0, s54, 147456
    s_nop 0
    buffer_load_dwordx4 v1, s[4:7], s52 offen lds
    s_add_u32 m0, s54, 148480
    s_nop 0
    buffer_load_dwordx4 v2, s[4:7], s52 offen lds
    s_add_u32 s52, s52, 128
    s_cmp_eq_u32 s52, 1280
    s_cselect_b32 s52, 0, s52
    s_add_u32 m0, s55, 65536
    s_nop 0
    buffer_load_dwordx4 v3, s[8:11], s53 offen offset:0 lds
    s_add_u32 m0, s55, 66432
    s_nop 0
    buffer_load_dwordx4 v3, s[8:11], s53 offen offset:128 lds
    s_add_u32 m0, s55, 67328
    s_nop 0
    buffer_load_dwordx4 v3, s[8:11], s53 offen offset:256 lds
    s_add_u32 s53, s53, 98304
    s_waitcnt vmcnt(5) lgkmcnt(0)
    s_barrier
    v_mfma_f32_16x16x32_bf16 v[4:7], v[64:67], v[76:79], 0
    s_add_u32 m0, s55, 77824
    ds_read_b64_tr_b16 v[92:93], v241 offset:61440
    v_mfma_f32_16x16x32_bf16 v[8:11], v[64:67], v[80:83], 0
    buffer_load_dwordx4 v3, s[8:11], s53 offen offset:0 lds
    ds_read_b64_tr_b16 v[94:95], v241 offset:61952
    v_mfma_f32_16x16x32_bf16 v[12:15], v[64:67], v[84:87], 0
    s_add_u32 m0, s55, 78720
    ds_read_b64_tr_b16 v[96:97], v242 offset:61440
    v_mfma_f32_16x16x32_bf16 v[16:19], v[64:67], v[88:91], 0
    buffer_load_dwordx4 v3, s[8:11], s53 offen offset:128 lds
    ds_read_b64_tr_b16 v[98:99], v242 offset:61952
    v_mfma_f32_16x16x32_bf16 v[52:55], v[64:67], v[244:247], 0
    ds_read_b64_tr_b16 v[100:101], v243 offset:61440
    ds_read_b64_tr_b16 v[102:103], v243 offset:61952
    v_mfma_f32_16x16x32_bf16 v[20:23], v[68:71], v[76:79], 0
    s_add_u32 m0, s55, 79616
    ds_read_b128 v[104:107], v127 offset:0
    v_mfma_f32_16x16x32_bf16 v[24:27], v[68:71], v[80:83], 0
    buffer_load_dwordx4 v3, s[8:11], s53 offen offset:256 lds
    s_add_u32 s53, s53, 98304
    s_cmp_eq_u32 s53, 1966080
    s_cselect_b32 s53, 0, s53
    v_mfma_f32_16x16x32_bf16 v[28:31], v[68:71], v[84:87], 0
    ds_read_b128 v[108:111], v127 offset:2048
    ds_read_b128 v[112:115], v127 offset:4096
    v_mfma_f32_16x16x32_bf16 v[32:35], v[68:71], v[88:91], 0
    s_add_u32 m0, s54, 155648
    ds_read_b128 v[116:119], v127 offset:6144
    v_mfma_f32_16x16x32_bf16 v[56:59], v[68:71], v[244:247], 0
    buffer_load_dwordx4 v1, s[4:7], s52 offen lds
    v_mfma_f32_16x16x32_bf16 v[36:39], v[72:75], v[76:79], 0
    v_mfma_f32_16x16x32_bf16 v[40:43], v[72:75], v[80:83], 0
    s_add_u32 m0, s54, 156672
    v_mfma_f32_16x16x32_bf16 v[44:47], v[72:75], v[84:87], 0
    buffer_load_dwordx4 v2, s[4:7], s52 offen lds
    s_add_u32 s52, s52, 128
    s_cmp_eq_u32 s52, 1280
    s_cselect_b32 s52, 0, s52
    v_mfma_f32_16x16x32_bf16 v[48:51], v[72:75], v[88:91], 0
    v_mfma_f32_16x16x32_bf16 v[60:63], v[72:75], v[244:247], 0
    s_waitcnt vmcnt(5) lgkmcnt(0)
    s_barrier
    v_mfma_f32_16x16x32_bf16 v[4:7], v[92:95], v[104:107], v[4:7]
    s_add_u32 m0, s55, 90112
    ds_read_b64_tr_b16 v[64:65], v241 offset:0
    v_mfma_f32_16x16x32_bf16 v[8:11], v[92:95], v[108:111], v[8:11]
    buffer_load_dwordx4 v3, s[8:11], s53 offen offset:0 lds
    ds_read_b64_tr_b16 v[66:67], v241 offset:512
    v_mfma_f32_16x16x32_bf16 v[12:15], v[92:95], v[112:115], v[12:15]
    s_add_u32 m0, s55, 91008
    ds_read_b64_tr_b16 v[68:69], v242 offset:0
    v_mfma_f32_16x16x32_bf16 v[16:19], v[92:95], v[116:119], v[16:19]
    buffer_load_dwordx4 v3, s[8:11], s53 offen offset:128 lds
    ds_read_b64_tr_b16 v[70:71], v242 offset:512
    v_mfma_f32_16x16x32_bf16 v[52:55], v[92:95], v[244:247], v[52:55]
    ds_read_b64_tr_b16 v[72:73], v243 offset:0
    ds_read_b64_tr_b16 v[74:75], v243 offset:512
    v_mfma_f32_16x16x32_bf16 v[20:23], v[96:99], v[104:107], v[20:23]
    s_add_u32 m0, s55, 91904
    ds_read_b128 v[76:79], v126 offset:8192
    v_mfma_f32_16x16x32_bf16 v[24:27], v[96:99], v[108:111], v[24:27]
    buffer_load_dwordx4 v3, s[8:11], s53 offen offset:256 lds
    s_add_u32 s53, s53, 98304
    v_mfma_f32_16x16x32_bf16 v[28:31], v[96:99], v[112:115], v[28:31]
    ds_read_b128 v[80:83], v126 offset:10240
    ds_read_b128 v[84:87], v126 offset:12288
    v_mfma_f32_16x16x32_bf16 v[32:35], v[96:99], v[116:119], v[32:35]
    s_add_u32 m0, s55, 102400
    ds_read_b128 v[88:91], v126 offset:14336
    v_mfma_f32_16x16x32_bf16 v[56:59], v[96:99], v[244:247], v[56:59]
    buffer_load_dwordx4 v3, s[8:11], s53 offen offset:0 lds
    v_mfma_f32_16x16x32_bf16 v[36:39], v[100:103], v[104:107], v[36:39]
    v_mfma_f32_16x16x32_bf16 v[40:43], v[100:103], v[108:111], v[40:43]
    s_add_u32 m0, s55, 103296
    v_mfma_f32_16x16x32_bf16 v[44:47], v[100:103], v[112:115], v[44:47]
    buffer_load_dwordx4 v3, s[8:11], s53 offen offset:128 lds
    v_mfma_f32_16x16x32_bf16 v[48:51], v[100:103], v[116:119], v[48:51]
    v_mfma_f32_16x16x32_bf16 v[60:63], v[100:103], v[244:247], v[60:63]
    s_waitcnt vmcnt(7) lgkmcnt(0)
    s_barrier
    v_mfma_f32_16x16x32_bf16 v[4:7], v[64:67], v[76:79], v[4:7]
    s_add_u32 m0, s55, 104192
    ds_read_b64_tr_b16 v[92:93], v241 offset:12288
    v_mfma_f32_16x16x32_bf16 v[8:11], v[64:67], v[80:83], v[8:11]
    buffer_load_dwordx4 v3, s[8:11], s53 offen offset:256 lds
    s_add_u32 s53, s53, 98304
    s_cmp_eq_u32 s53, 1966080
    s_cselect_b32 s53, 0, s53
    v_mfma_f32_16x16x32_bf16 v[12:15], v[64:67], v[84:87], v[12:15]
    s_add_u32 m0, s55, 114688
    ds_read_b64_tr_b16 v[94:95], v241 offset:12800
    v_mfma_f32_16x16x32_bf16 v[16:19], v[64:67], v[88:91], v[16:19]
    buffer_load_dwordx4 v3, s[8:11], s53 offen offset:0 lds
    ds_read_b64_tr_b16 v[96:97], v242 offset:12288
    v_mfma_f32_16x16x32_bf16 v[52:55], v[64:67], v[244:247], v[52:55]
    ds_read_b64_tr_b16 v[98:99], v242 offset:12800
    ds_read_b64_tr_b16 v[100:101], v243 offset:12288
    v_mfma_f32_16x16x32_bf16 v[20:23], v[68:71], v[76:79], v[20:23]
    s_add_u32 m0, s55, 115584
    ds_read_b64_tr_b16 v[102:103], v243 offset:12800
    v_mfma_f32_16x16x32_bf16 v[24:27], v[68:71], v[80:83], v[24:27]
    buffer_load_dwordx4 v3, s[8:11], s53 offen offset:128 lds
    ds_read_b128 v[104:107], v127 offset:8192
    v_mfma_f32_16x16x32_bf16 v[28:31], v[68:71], v[84:87], v[28:31]
    ds_read_b128 v[108:111], v127 offset:10240
    ds_read_b128 v[112:115], v127 offset:12288
    v_mfma_f32_16x16x32_bf16 v[32:35], v[68:71], v[88:91], v[32:35]
    s_add_u32 m0, s55, 116480
    ds_read_b128 v[116:119], v127 offset:14336
    v_mfma_f32_16x16x32_bf16 v[56:59], v[68:71], v[244:247], v[56:59]
    buffer_load_dwordx4 v3, s[8:11], s53 offen offset:256 lds
    s_add_u32 s53, s53, 98304
    v_mfma_f32_16x16x32_bf16 v[36:39], v[72:75], v[76:79], v[36:39]
    v_mfma_f32_16x16x32_bf16 v[40:43], v[72:75], v[80:83], v[40:43]
    s_add_u32 m0, s54, 139264
    v_mfma_f32_16x16x32_bf16 v[44:47], v[72:75], v[84:87], v[44:47]
    buffer_load_dwordx4 v1, s[4:7], s52 offen lds
    v_mfma_f32_16x16x32_bf16 v[48:51], v[72:75], v[88:91], v[48:51]
    v_mfma_f32_16x16x32_bf16 v[60:63], v[72:75], v[244:247], v[60:63]
    s_waitcnt vmcnt(7) lgkmcnt(0)
    s_barrier
    v_mfma_f32_16x16x32_bf16 v[4:7], v[92:95], v[104:107], v[4:7]
    s_add_u32 m0, s54, 140288
    ds_read_b64_tr_b16 v[64:65], v241 offset:24576
    v_mfma_f32_16x16x32_bf16 v[8:11], v[92:95], v[108:111], v[8:11]
    buffer_load_dwordx4 v2, s[4:7], s52 offen lds
    s_add_u32 s52, s52, 128
    s_cmp_eq_u32 s52, 1280
    s_cselect_b32 s52, 0, s52
    v_mfma_f32_16x16x32_bf16 v[12:15], v[92:95], v[112:115], v[12:15]
    s_add_u32 m0, s55, 126976
    ds_read_b64_tr_b16 v[66:67], v241 offset:25088
    v_mfma_f32_16x16x32_bf16 v[16:19], v[92:95], v[116:119], v[16:19]
    buffer_load_dwordx4 v3, s[8:11], s53 offen offset:0 lds
    ds_read_b64_tr_b16 v[68:69], v242 offset:24576
    v_mfma_f32_16x16x32_bf16 v[52:55], v[92:95], v[244:247], v[52:55]
    ds_read_b64_tr_b16 v[70:71], v242 offset:25088
    ds_read_b64_tr_b16 v[72:73], v243 offset:24576
    v_mfma_f32_16x16x32_bf16 v[20:23], v[96:99], v[104:107], v[20:23]
    s_add_u32 m0, s55, 127872
    ds_read_b64_tr_b16 v[74:75], v243 offset:25088
    v_mfma_f32_16x16x32_bf16 v[24:27], v[96:99], v[108:111], v[24:27]
    buffer_load_dwordx4 v3, s[8:11], s53 offen offset:128 lds
    ds_read_b128 v[76:79], v126 offset:16384
    v_mfma_f32_16x16x32_bf16 v[28:31], v[96:99], v[112:115], v[28:31]
    ds_read_b128 v[80:83], v126 offset:18432
    ds_read_b128 v[84:87], v126 offset:20480
    v_mfma_f32_16x16x32_bf16 v[32:35], v[96:99], v[116:119], v[32:35]
    s_add_u32 m0, s55, 128768
    ds_read_b128 v[88:91], v126 offset:22528
    v_mfma_f32_16x16x32_bf16 v[56:59], v[96:99], v[244:247], v[56:59]
    buffer_load_dwordx4 v3, s[8:11], s53 offen offset:256 lds
    s_add_u32 s53, s53, 98304
    s_cmp_eq_u32 s53, 1966080
    s_cselect_b32 s53, 0, s53
    v_mfma_f32_16x16x32_bf16 v[36:39], v[100:103], v[104:107], v[36:39]
    v_mfma_f32_16x16x32_bf16 v[40:43], v[100:103], v[108:111], v[40:43]
    s_add_u32 m0, s55, 65536
    v_mfma_f32_16x16x32_bf16 v[44:47], v[100:103], v[112:115], v[44:47]
    buffer_load_dwordx4 v3, s[8:11], s53 offen offset:0 lds
    v_mfma_f32_16x16x32_bf16 v[48:51], v[100:103], v[116:119], v[48:51]
    v_mfma_f32_16x16x32_bf16 v[60:63], v[100:103], v[244:247], v[60:63]
    s_waitcnt vmcnt(9) lgkmcnt(0)
    s_barrier
    v_mfma_f32_16x16x32_bf16 v[4:7], v[64:67], v[76:79], v[4:7]
    s_add_u32 m0, s55, 66432
    ds_read_b64_tr_b16 v[92:93], v241 offset:36864
    v_mfma_f32_16x16x32_bf16 v[8:11], v[64:67], v[80:83], v[8:11]
    buffer_load_dwordx4 v3, s[8:11], s53 offen offset:128 lds
    ds_read_b64_tr_b16 v[94:95], v241 offset:37376
    v_mfma_f32_16x16x32_bf16 v[12:15], v[64:67], v[84:87], v[12:15]
    s_add_u32 m0, s55, 67328
    ds_read_b64_tr_b16 v[96:97], v242 offset:36864
    v_mfma_f32_16x16x32_bf16 v[16:19], v[64:67], v[88:91], v[16:19]
    buffer_load_dwordx4 v3, s[8:11], s53 offen offset:256 lds
    s_add_u32 s53, s53, 98304
    v_mfma_f32_16x16x32_bf16 v[52:55], v[64:67], v[244:247], v[52:55]
    ds_read_b64_tr_b16 v[98:99], v242 offset:37376
    ds_read_b64_tr_b16 v[100:101], v243 offset:36864
    v_mfma_f32_16x16x32_bf16 v[20:23], v[68:71], v[76:79], v[20:23]
    s_add_u32 m0, s54, 147456
    ds_read_b64_tr_b16 v[102:103], v243 offset:37376
    v_mfma_f32_16x16x32_bf16 v[24:27], v[68:71], v[80:83], v[24:27]
    buffer_load_dwordx4 v1, s[4:7], s52 offen lds
    ds_read_b128 v[104:107], v127 offset:16384
    v_mfma_f32_16x16x32_bf16 v[28:31], v[68:71], v[84:87], v[28:31]
    ds_read_b128 v[108:111], v127 offset:18432
    ds_read_b128 v[112:115], v127 offset:20480
    v_mfma_f32_16x16x32_bf16 v[32:35], v[68:71], v[88:91], v[32:35]
    s_add_u32 m0, s54, 148480
    ds_read_b128 v[116:119], v127 offset:22528
    v_mfma_f32_16x16x32_bf16 v[56:59], v[68:71], v[244:247], v[56:59]
    buffer_load_dwordx4 v2, s[4:7], s52 offen lds
    s_add_u32 s52, s52, 128
    s_cmp_eq_u32 s52, 1280
    s_cselect_b32 s52, 0, s52
    v_mfma_f32_16x16x32_bf16 v[36:39], v[72:75], v[76:79], v[36:39]
    v_mfma_f32_16x16x32_bf16 v[40:43], v[72:75], v[80:83], v[40:43]
    s_add_u32 m0, s55, 77824
    v_mfma_f32_16x16x32_bf16 v[44:47], v[72:75], v[84:87], v[44:47]
    buffer_load_dwordx4 v3, s[8:11], s53 offen offset:0 lds
    v_mfma_f32_16x16x32_bf16 v[48:51], v[72:75], v[88:91], v[48:51]
    v_mfma_f32_16x16x32_bf16 v[60:63], v[72:75], v[244:247], v[60:63]
    s_waitcnt vmcnt(9) lgkmcnt(0)
    s_barrier
    v_mfma_f32_16x16x32_bf16 v[4:7], v[92:95], v[104:107], v[4:7]
    s_add_u32 m0, s55, 78720
    ds_read_b64_tr_b16 v[64:65], v241 offset:49152
    v_mfma_f32_16x16x32_bf16 v[8:11], v[92:95], v[108:111], v[8:11]
    buffer_load_dwordx4 v3, s[8:11], s53 offen offset:128 lds
    ds_read_b64_tr_b16 v[66:67], v241 offset:49664
    v_mfma_f32_16x16x32_bf16 v[12:15], v[92:95], v[112:115], v[12:15]
    s_add_u32 m0, s55, 79616
    ds_read_b64_tr_b16 v[68:69], v242 offset:49152
    v_mfma_f32_16x16x32_bf16 v[16:19], v[92:95], v[116:119], v[16:19]
    buffer_load_dwordx4 v3, s[8:11], s53 offen offset:256 lds
    s_add_u32 s53, s53, 98304
    s_cmp_eq_u32 s53, 1966080
    s_cselect_b32 s53, 0, s53
    v_mfma_f32_16x16x32_bf16 v[52:55], v[92:95], v[244:247], v[52:55]
    ds_read_b64_tr_b16 v[70:71], v242 offset:49664
    ds_read_b64_tr_b16 v[72:73], v243 offset:49152
    v_mfma_f32_16x16x32_bf16 v[20:23], v[96:99], v[104:107], v[20:23]
    s_add_u32 m0, s55, 90112
    ds_read_b64_tr_b16 v[74:75], v243 offset:49664
    v_mfma_f32_16x16x32_bf16 v[24:27], v[96:99], v[108:111], v[24:27]
    buffer_load_dwordx4 v3, s[8:11], s53 offen offset:0 lds
    ds_read_b128 v[76:79], v126 offset:0
    v_mfma_f32_16x16x32_bf16 v[28:31], v[96:99], v[112:115], v[28:31]
    ds_read_b128 v[80:83], v126 offset:2048
    ds_read_b128 v[84:87], v126 offset:4096
    v_mfma_f32_16x16x32_bf16 v[32:35], v[96:99], v[116:119], v[32:35]
    s_add_u32 m0, s55, 91008
    ds_read_b128 v[88:91], v126 offset:6144
    v_mfma_f32_16x16x32_bf16 v[56:59], v[96:99], v[244:247], v[56:59]
    buffer_load_dwordx4 v3, s[8:11], s53 offen offset:128 lds
    v_mfma_f32_16x16x32_bf16 v[36:39], v[100:103], v[104:107], v[36:39]
    v_mfma_f32_16x16x32_bf16 v[40:43], v[100:103], v[108:111], v[40:43]
    s_add_u32 m0, s55, 91904
    v_mfma_f32_16x16x32_bf16 v[44:47], v[100:103], v[112:115], v[44:47]
    buffer_load_dwordx4 v3, s[8:11], s53 offen offset:256 lds
    s_add_u32 s53, s53, 98304
    v_mfma_f32_16x16x32_bf16 v[48:51], v[100:103], v[116:119], v[48:51]
    v_mfma_f32_16x16x32_bf16 v[60:63], v[100:103], v[244:247], v[60:63]
    s_waitcnt vmcnt(11) lgkmcnt(0)
    s_barrier
    v_mfma_f32_16x16x32_bf16 v[4:7], v[64:67], v[76:79], v[4:7]
    s_add_u32 m0, s54, 155648
    ds_read_b64_tr_b16 v[92:93], v241 offset:61440
    v_mfma_f32_16x16x32_bf16 v[8:11], v[64:67], v[80:83], v[8:11]
    buffer_load_dwordx4 v1, s[4:7], s52 offen lds
    ds_read_b64_tr_b16 v[94:95], v241 offset:61952
    v_mfma_f32_16x16x32_bf16 v[12:15], v[64:67], v[84:87], v[12:15]
    s_add_u32 m0, s54, 156672
    ds_read_b64_tr_b16 v[96:97], v242 offset:61440
    v_mfma_f32_16x16x32_bf16 v[16:19], v[64:67], v[88:91], v[16:19]
    buffer_load_dwordx4 v2, s[4:7], s52 offen lds
    s_add_u32 s52, s52, 128
    s_cmp_eq_u32 s52, 1280
    s_cselect_b32 s52, 0, s52
    v_mfma_f32_16x16x32_bf16 v[52:55], v[64:67], v[244:247], v[52:55]
    ds_read_b64_tr_b16 v[98:99], v242 offset:61952
    ds_read_b64_tr_b16 v[100:101], v243 offset:61440
    v_mfma_f32_16x16x32_bf16 v[20:23], v[68:71], v[76:79], v[20:23]
    s_add_u32 m0, s55, 102400
    ds_read_b64_tr_b16 v[102:103], v243 offset:61952
    v_mfma_f32_16x16x32_bf16 v[24:27], v[68:71], v[80:83], v[24:27]
    buffer_load_dwordx4 v3, s[8:11], s53 offen offset:0 lds
    ds_read_b128 v[104:107], v127 offset:0
    v_mfma_f32_16x16x32_bf16 v[28:31], v[68:71], v[84:87], v[28:31]
    ds_read_b128 v[108:111], v127 offset:2048
    ds_read_b128 v[112:115], v127 offset:4096
    v_mfma_f32_16x16x32_bf16 v[32:35], v[68:71], v[88:91], v[32:35]
    s_add_u32 m0, s55, 103296
    ds_read_b128 v[116:119], v127 offset:6144
    v_mfma_f32_16x16x32_bf16 v[56:59], v[68:71], v[244:247], v[56:59]
    buffer_load_dwordx4 v3, s[8:11], s53 offen offset:128 lds
    v_mfma_f32_16x16x32_bf16 v[36:39], v[72:75], v[76:79], v[36:39]
    v_mfma_f32_16x16x32_bf16 v[40:43], v[72:75], v[80:83], v[40:43]
    s_add_u32 m0, s55, 104192
    v_mfma_f32_16x16x32_bf16 v[44:47], v[72:75], v[84:87], v[44:47]
    buffer_load_dwordx4 v3, s[8:11], s53 offen offset:256 lds
    s_add_u32 s53, s53, 98304
    s_cmp_eq_u32 s53, 1966080
    s_cselect_b32 s53, 0, s53
    v_mfma_f32_16x16x32_bf16 v[48:51], v[72:75], v[88:91], v[48:51]
    v_mfma_f32_16x16x32_bf16 v[60:63], v[72:75], v[244:247], v[60:63]
    s_waitcnt vmcnt(11) lgkmcnt(0)
    s_barrier
    v_mfma_f32_16x16x32_bf16 v[4:7], v[92:95], v[104:107], v[4:7]
    s_add_u32 m0, s55, 114688
    ds_read_b64_tr_b16 v[64:65], v241 offset:0
    v_mfma_f32_16x16x32_bf16 v[8:11], v[92:95], v[108:111], v[8:11]
    buffer_load_dwordx4 v3, s[8:11], s53 offen offset:0 lds
    ds_read_b64_tr_b16 v[66:67], v241 offset:512
    v_mfma_f32_16x16x32_bf16 v[12:15], v[92:95], v[112:115], v[12:15]
    s_add_u32 m0, s55, 115584
    ds_read_b64_tr_b16 v[68:69], v242 offset:0
    v_mfma_f32_16x16x32_bf16 v[16:19], v[92:95], v[116:119], v[16:19]
    buffer_load_dwordx4 v3, s[8:11], s53 offen offset:128 lds
    ds_read_b64_tr_b16 v[70:71], v242 offset:512
    v_mfma_f32_16x16x32_bf16 v[52:55], v[92:95], v[244:247], v[52:55]
    ds_read_b64_tr_b16 v[72:73], v243 offset:0
    ds_read_b64_tr_b16 v[74:75], v243 offset:512
    v_mfma_f32_16x16x32_bf16 v[20:23], v[96:99], v[104:107], v[20:23]
    s_add_u32 m0, s55, 116480
    ds_read_b128 v[76:79], v126 offset:8192
    v_mfma_f32_16x16x32_bf16 v[24:27], v[96:99], v[108:111], v[24:27]
    buffer_load_dwordx4 v3, s[8:11], s53 offen offset:256 lds
    s_add_u32 s53, s53, 98304
    v_mfma_f32_16x16x32_bf16 v[28:31], v[96:99], v[112:115], v[28:31]
    ds_read_b128 v[80:83], v126 offset:10240
    ds_read_b128 v[84:87], v126 offset:12288
    v_mfma_f32_16x16x32_bf16 v[32:35], v[96:99], v[116:119], v[32:35]
    s_add_u32 m0, s54, 139264
    ds_read_b128 v[88:91], v126 offset:14336
    v_mfma_f32_16x16x32_bf16 v[56:59], v[96:99], v[244:247], v[56:59]
    buffer_load_dwordx4 v1, s[4:7], s52 offen lds
    v_mfma_f32_16x16x32_bf16 v[36:39], v[100:103], v[104:107], v[36:39]
    v_mfma_f32_16x16x32_bf16 v[40:43], v[100:103], v[108:111], v[40:43]
    s_add_u32 m0, s54, 140288
    v_mfma_f32_16x16x32_bf16 v[44:47], v[100:103], v[112:115], v[44:47]
    buffer_load_dwordx4 v2, s[4:7], s52 offen lds
    s_add_u32 s52, s52, 128
    s_cmp_eq_u32 s52, 1280
    s_cselect_b32 s52, 0, s52
    v_mfma_f32_16x16x32_bf16 v[48:51], v[100:103], v[116:119], v[48:51]
    v_mfma_f32_16x16x32_bf16 v[60:63], v[100:103], v[244:247], v[60:63]
    s_waitcnt vmcnt(13) lgkmcnt(0)
    s_barrier
    v_mfma_f32_16x16x32_bf16 v[4:7], v[64:67], v[76:79], v[4:7]
    s_add_u32 m0, s55, 126976
    ds_read_b64_tr_b16 v[92:93], v241 offset:12288
    v_mfma_f32_16x16x32_bf16 v[8:11], v[64:67], v[80:83], v[8:11]
    buffer_load_dwordx4 v3, s[8:11], s53 offen offset:0 lds
    ds_read_b64_tr_b16 v[94:95], v241 offset:12800
    v_mfma_f32_16x16x32_bf16 v[12:15], v[64:67], v[84:87], v[12:15]
    s_add_u32 m0, s55, 127872
    ds_read_b64_tr_b16 v[96:97], v242 offset:12288
    v_mfma_f32_16x16x32_bf16 v[16:19], v[64:67], v[88:91], v[16:19]
    buffer_load_dwordx4 v3, s[8:11], s53 offen offset:128 lds
    ds_read_b64_tr_b16 v[98:99], v242 offset:12800
    v_mfma_f32_16x16x32_bf16 v[52:55], v[64:67], v[244:247], v[52:55]
    ds_read_b64_tr_b16 v[100:101], v243 offset:12288
    ds_read_b64_tr_b16 v[102:103], v243 offset:12800
    v_mfma_f32_16x16x32_bf16 v[20:23], v[68:71], v[76:79], v[20:23]
    s_add_u32 m0, s55, 128768
    ds_read_b128 v[104:107], v127 offset:8192
    v_mfma_f32_16x16x32_bf16 v[24:27], v[68:71], v[80:83], v[24:27]
    buffer_load_dwordx4 v3, s[8:11], s53 offen offset:256 lds
    s_add_u32 s53, s53, 98304
    s_cmp_eq_u32 s53, 1966080
    s_cselect_b32 s53, 0, s53
    v_mfma_f32_16x16x32_bf16 v[28:31], v[68:71], v[84:87], v[28:31]
    ds_read_b128 v[108:111], v127 offset:10240
    ds_read_b128 v[112:115], v127 offset:12288
    v_mfma_f32_16x16x32_bf16 v[32:35], v[68:71], v[88:91], v[32:35]
    s_add_u32 m0, s55, 65536
    ds_read_b128 v[116:119], v127 offset:14336
    v_mfma_f32_16x16x32_bf16 v[56:59], v[68:71], v[244:247], v[56:59]
    buffer_load_dwordx4 v3, s[8:11], s53 offen offset:0 lds
    v_mfma_f32_16x16x32_bf16 v[36:39], v[72:75], v[76:79], v[36:39]
    v_mfma_f32_16x16x32_bf16 v[40:43], v[72:75], v[80:83], v[40:43]
    s_add_u32 m0, s55, 66432
    v_mfma_f32_16x16x32_bf16 v[44:47], v[72:75], v[84:87], v[44:47]
    buffer_load_dwordx4 v3, s[8:11], s53 offen offset:128 lds
    v_mfma_f32_16x16x32_bf16 v[48:51], v[72:75], v[88:91], v[48:51]
    v_mfma_f32_16x16x32_bf16 v[60:63], v[72:75], v[244:247], v[60:63]
    s_waitcnt vmcnt(13) lgkmcnt(0)
    s_barrier
    v_mfma_f32_16x16x32_bf16 v[4:7], v[92:95], v[104:107], v[4:7]
    s_add_u32 m0, s55, 67328
    ds_read_b64_tr_b16 v[64:65], v241 offset:24576
    v_mfma_f32_16x16x32_bf16 v[8:11], v[92:95], v[108:111], v[8:11]
    buffer_load_dwordx4 v3, s[8:11], s53 offen offset:256 lds
    s_add_u32 s53, s53, 98304
    v_mfma_f32_16x16x32_bf16 v[12:15], v[92:95], v[112:115], v[12:15]
    s_add_u32 m0, s54, 147456
    ds_read_b64_tr_b16 v[66:67], v241 offset:25088
    v_mfma_f32_16x16x32_bf16 v[16:19], v[92:95], v[116:119], v[16:19]
    buffer_load_dwordx4 v1, s[4:7], s52 offen lds
    ds_read_b64_tr_b16 v[68:69], v242 offset:24576
    v_mfma_f32_16x16x32_bf16 v[52:55], v[92:95], v[244:247], v[52:55]
    ds_read_b64_tr_b16 v[70:71], v242 offset:25088
    ds_read_b64_tr_b16 v[72:73], v243 offset:24576
    v_mfma_f32_16x16x32_bf16 v[20:23], v[96:99], v[104:107], v[20:23]
    s_add_u32 m0, s54, 148480
    ds_read_b64_tr_b16 v[74:75], v243 offset:25088
    v_mfma_f32_16x16x32_bf16 v[24:27], v[96:99], v[108:111], v[24:27]
    buffer_load_dwordx4 v2, s[4:7], s52 offen lds
    s_add_u32 s52, s52, 128
    s_cmp_eq_u32 s52, 1280
    s_cselect_b32 s52, 0, s52
    v_mfma_f32_16x16x32_bf16 v[28:31], v[96:99], v[112:115], v[28:31]
    ds_read_b128 v[76:79], v126 offset:16384
    ds_read_b128 v[80:83], v126 offset:18432
    v_mfma_f32_16x16x32_bf16 v[32:35], v[96:99], v[116:119], v[32:35]
    s_add_u32 m0, s55, 77824
    ds_read_b128 v[84:87], v126 offset:20480
    v_mfma_f32_16x16x32_bf16 v[56:59], v[96:99], v[244:247], v[56:59]
    buffer_load_dwordx4 v3, s[8:11], s53 offen offset:0 lds
    ds_read_b128 v[88:91], v126 offset:22528
    v_mfma_f32_16x16x32_bf16 v[36:39], v[100:103], v[104:107], v[36:39]
    v_mfma_f32_16x16x32_bf16 v[40:43], v[100:103], v[108:111], v[40:43]
    s_add_u32 m0, s55, 78720
    v_mfma_f32_16x16x32_bf16 v[44:47], v[100:103], v[112:115], v[44:47]
    buffer_load_dwordx4 v3, s[8:11], s53 offen offset:128 lds
    v_mfma_f32_16x16x32_bf16 v[48:51], v[100:103], v[116:119], v[48:51]
    v_mfma_f32_16x16x32_bf16 v[60:63], v[100:103], v[244:247], v[60:63]
    s_waitcnt vmcnt(15) lgkmcnt(0)
    s_barrier
    v_mfma_f32_16x16x32_bf16 v[4:7], v[64:67], v[76:79], v[4:7]
    s_add_u32 m0, s55, 79616
    ds_read_b64_tr_b16 v[92:93], v241 offset:36864
    v_mfma_f32_16x16x32_bf16 v[8:11], v[64:67], v[80:83], v[8:11]
    buffer_load_dwordx4 v3, s[8:11], s53 offen offset:256 lds
    s_add_u32 s53, s53, 98304
    s_cmp_eq_u32 s53, 1966080
    s_cselect_b32 s53, 0, s53
    v_mfma_f32_16x16x32_bf16 v[12:15], v[64:67], v[84:87], v[12:15]
    ds_read_b64_tr_b16 v[94:95], v241 offset:37376
    ds_read_b64_tr_b16 v[96:97], v242 offset:36864
    v_mfma_f32_16x16x32_bf16 v[16:19], v[64:67], v[88:91], v[16:19]
    s_add_u32 m0, s55, 90112
    ds_read_b64_tr_b16 v[98:99], v242 offset:37376
    v_mfma_f32_16x16x32_bf16 v[52:55], v[64:67], v[244:247], v[52:55]
    buffer_load_dwordx4 v3, s[8:11], s53 offen offset:0 lds
    ds_read_b64_tr_b16 v[100:101], v243 offset:36864
    v_mfma_f32_16x16x32_bf16 v[20:23], v[68:71], v[76:79], v[20:23]
    ds_read_b64_tr_b16 v[102:103], v243 offset:37376
    ds_read_b128 v[104:107], v127 offset:16384
    v_mfma_f32_16x16x32_bf16 v[24:27], v[68:71], v[80:83], v[24:27]
    ds_read_b128 v[108:111], v127 offset:18432
    ds_read_b128 v[112:115], v127 offset:20480
    v_mfma_f32_16x16x32_bf16 v[28:31], v[68:71], v[84:87], v[28:31]
    s_add_u32 m0, s55, 91008
    ds_read_b128 v[116:119], v127 offset:22528
    v_mfma_f32_16x16x32_bf16 v[32:35], v[68:71], v[88:91], v[32:35]
    buffer_load_dwordx4 v3, s[8:11], s53 offen offset:128 lds
    v_mfma_f32_16x16x32_bf16 v[56:59], v[68:71], v[244:247], v[56:59]
    v_mfma_f32_16x16x32_bf16 v[36:39], v[72:75], v[76:79], v[36:39]
    s_add_u32 m0, s55, 91904
    v_mfma_f32_16x16x32_bf16 v[40:43], v[72:75], v[80:83], v[40:43]
    buffer_load_dwordx4 v3, s[8:11], s53 offen offset:256 lds
    s_add_u32 s53, s53, 98304
    v_mfma_f32_16x16x32_bf16 v[44:47], v[72:75], v[84:87], v[44:47]
    v_mfma_f32_16x16x32_bf16 v[48:51], v[72:75], v[88:91], v[48:51]
    v_mfma_f32_16x16x32_bf16 v[60:63], v[72:75], v[244:247], v[60:63]
    s_waitcnt vmcnt(14) lgkmcnt(0)
    s_barrier
    v_mfma_f32_16x16x32_bf16 v[4:7], v[92:95], v[104:107], v[4:7]
    s_add_u32 m0, s54, 155648
    ds_read_b64_tr_b16 v[64:65], v241 offset:49152
    v_mfma_f32_16x16x32_bf16 v[8:11], v[92:95], v[108:111], v[8:11]
    buffer_load_dwordx4 v1, s[4:7], s52 offen lds
    ds_read_b64_tr_b16 v[66:67], v241 offset:49664
    v_mfma_f32_16x16x32_bf16 v[12:15], v[92:95], v[112:115], v[12:15]
    ds_read_b64_tr_b16 v[68:69], v242 offset:49152
    ds_read_b64_tr_b16 v[70:71], v242 offset:49664
    v_mfma_f32_16x16x32_bf16 v[16:19], v[92:95], v[116:119], v[16:19]
    s_add_u32 m0, s54, 156672
    ds_read_b64_tr_b16 v[72:73], v243 offset:49152
    v_mfma_f32_16x16x32_bf16 v[52:55], v[92:95], v[244:247], v[52:55]
    buffer_load_dwordx4 v2, s[4:7], s52 offen lds
    s_add_u32 s52, s52, 128
    s_cmp_eq_u32 s52, 1280
    s_cselect_b32 s52, 0, s52
    v_mfma_f32_16x16x32_bf16 v[20:23], v[96:99], v[104:107], v[20:23]
    ds_read_b64_tr_b16 v[74:75], v243 offset:49664
    ds_read_b128 v[76:79], v126 offset:0
    v_mfma_f32_16x16x32_bf16 v[24:27], v[96:99], v[108:111], v[24:27]
    ds_read_b128 v[80:83], v126 offset:2048
    ds_read_b128 v[84:87], v126 offset:4096
    v_mfma_f32_16x16x32_bf16 v[28:31], v[96:99], v[112:115], v[28:31]
    s_add_u32 m0, s55, 102400
    ds_read_b128 v[88:91], v126 offset:6144
    v_mfma_f32_16x16x32_bf16 v[32:35], v[96:99], v[116:119], v[32:35]
    buffer_load_dwordx4 v3, s[8:11], s53 offen offset:0 lds
    v_mfma_f32_16x16x32_bf16 v[56:59], v[96:99], v[244:247], v[56:59]
    v_mfma_f32_16x16x32_bf16 v[36:39], v[100:103], v[104:107], v[36:39]
    s_add_u32 m0, s55, 103296
    v_mfma_f32_16x16x32_bf16 v[40:43], v[100:103], v[108:111], v[40:43]
    buffer_load_dwordx4 v3, s[8:11], s53 offen offset:128 lds
    v_mfma_f32_16x16x32_bf16 v[44:47], v[100:103], v[112:115], v[44:47]
    v_mfma_f32_16x16x32_bf16 v[48:51], v[100:103], v[116:119], v[48:51]
    v_mfma_f32_16x16x32_bf16 v[60:63], v[100:103], v[244:247], v[60:63]
    s_waitcnt vmcnt(15) lgkmcnt(0)
    s_barrier
    v_mfma_f32_16x16x32_bf16 v[4:7], v[64:67], v[76:79], v[4:7]
    s_add_u32 m0, s55, 104192
    ds_read_b64_tr_b16 v[92:93], v241 offset:61440
    v_mfma_f32_16x16x32_bf16 v[8:11], v[64:67], v[80:83], v[8:11]
    buffer_load_dwordx4 v3, s[8:11], s53 offen offset:256 lds
    s_add_u32 s53, s53, 98304
    s_cmp_eq_u32 s53, 1966080
    s_cselect_b32 s53, 0, s53
    v_mfma_f32_16x16x32_bf16 v[12:15], v[64:67], v[84:87], v[12:15]
    ds_read_b64_tr_b16 v[94:95], v241 offset:61952
    ds_read_b64_tr_b16 v[96:97], v242 offset:61440
    v_mfma_f32_16x16x32_bf16 v[16:19], v[64:67], v[88:91], v[16:19]
    s_add_u32 m0, s55, 114688
    ds_read_b64_tr_b16 v[98:99], v242 offset:61952
    v_mfma_f32_16x16x32_bf16 v[52:55], v[64:67], v[244:247], v[52:55]
    buffer_load_dwordx4 v3, s[8:11], s53 offen offset:0 lds
    ds_read_b64_tr_b16 v[100:101], v243 offset:61440
    v_mfma_f32_16x16x32_bf16 v[20:23], v[68:71], v[76:79], v[20:23]
    ds_read_b64_tr_b16 v[102:103], v243 offset:61952
    ds_read_b128 v[104:107], v127 offset:0
    v_mfma_f32_16x16x32_bf16 v[24:27], v[68:71], v[80:83], v[24:27]
    ds_read_b128 v[108:111], v127 offset:2048
    ds_read_b128 v[112:115], v127 offset:4096
    v_mfma_f32_16x16x32_bf16 v[28:31], v[68:71], v[84:87], v[28:31]
    s_add_u32 m0, s55, 115584
    ds_read_b128 v[116:119], v127 offset:6144
    v_mfma_f32_16x16x32_bf16 v[32:35], v[68:71], v[88:91], v[32:35]
    buffer_load_dwordx4 v3, s[8:11], s53 offen offset:128 lds
    v_mfma_f32_16x16x32_bf16 v[56:59], v[68:71], v[244:247], v[56:59]
    v_mfma_f32_16x16x32_bf16 v[36:39], v[72:75], v[76:79], v[36:39]
    s_add_u32 m0, s55, 116480
    v_mfma_f32_16x16x32_bf16 v[40:43], v[72:75], v[80:83], v[40:43]
    buffer_load_dwordx4 v3, s[8:11], s53 offen offset:256 lds
    s_add_u32 s53, s53, 98304
    v_mfma_f32_16x16x32_bf16 v[44:47], v[72:75], v[84:87], v[44:47]
    v_mfma_f32_16x16x32_bf16 v[48:51], v[72:75], v[88:91], v[48:51]
    v_mfma_f32_16x16x32_bf16 v[60:63], v[72:75], v[244:247], v[60:63]
    s_waitcnt vmcnt(14) lgkmcnt(0)
    s_barrier
    v_mfma_f32_16x16x32_bf16 v[4:7], v[92:95], v[104:107], v[4:7]
    s_add_u32 m0, s54, 139264
    ds_read_b64_tr_b16 v[64:65], v241 offset:0
    v_mfma_f32_16x16x32_bf16 v[8:11], v[92:95], v[108:111], v[8:11]
    buffer_load_dwordx4 v1, s[4:7], s52 offen lds
    ds_read_b64_tr_b16 v[66:67], v241 offset:512
    v_mfma_f32_16x16x32_bf16 v[12:15], v[92:95], v[112:115], v[12:15]
    ds_read_b64_tr_b16 v[68:69], v242 offset:0
    ds_read_b64_tr_b16 v[70:71], v242 offset:512
    v_mfma_f32_16x16x32_bf16 v[16:19], v[92:95], v[116:119], v[16:19]
    s_add_u32 m0, s54, 140288
    ds_read_b64_tr_b16 v[72:73], v243 offset:0
    v_mfma_f32_16x16x32_bf16 v[52:55], v[92:95], v[244:247], v[52:55]
    buffer_load_dwordx4 v2, s[4:7], s52 offen lds
    s_add_u32 s52, s52, 128
    s_cmp_eq_u32 s52, 1280
    s_cselect_b32 s52, 0, s52
    v_mfma_f32_16x16x32_bf16 v[20:23], v[96:99], v[104:107], v[20:23]
    ds_read_b64_tr_b16 v[74:75], v243 offset:512
    ds_read_b128 v[76:79], v126 offset:8192
    v_mfma_f32_16x16x32_bf16 v[24:27], v[96:99], v[108:111], v[24:27]
    ds_read_b128 v[80:83], v126 offset:10240
    ds_read_b128 v[84:87], v126 offset:12288
    v_mfma_f32_16x16x32_bf16 v[28:31], v[96:99], v[112:115], v[28:31]
    s_add_u32 m0, s55, 126976
    ds_read_b128 v[88:91], v126 offset:14336
    v_mfma_f32_16x16x32_bf16 v[32:35], v[96:99], v[116:119], v[32:35]
    buffer_load_dwordx4 v3, s[8:11], s53 offen offset:0 lds
    v_mfma_f32_16x16x32_bf16 v[56:59], v[96:99], v[244:247], v[56:59]
    v_mfma_f32_16x16x32_bf16 v[36:39], v[100:103], v[104:107], v[36:39]
    s_add_u32 m0, s55, 127872
    v_mfma_f32_16x16x32_bf16 v[40:43], v[100:103], v[108:111], v[40:43]
    buffer_load_dwordx4 v3, s[8:11], s53 offen offset:128 lds
    v_mfma_f32_16x16x32_bf16 v[44:47], v[100:103], v[112:115], v[44:47]
    v_mfma_f32_16x16x32_bf16 v[48:51], v[100:103], v[116:119], v[48:51]
    v_mfma_f32_16x16x32_bf16 v[60:63], v[100:103], v[244:247], v[60:63]
    s_waitcnt vmcnt(15) lgkmcnt(0)
    s_barrier
    v_mfma_f32_16x16x32_bf16 v[4:7], v[64:67], v[76:79], v[4:7]
    s_add_u32 m0, s55, 128768
    ds_read_b64_tr_b16 v[92:93], v241 offset:12288
    v_mfma_f32_16x16x32_bf16 v[8:11], v[64:67], v[80:83], v[8:11]
    buffer_load_dwordx4 v3, s[8:11], s53 offen offset:256 lds
    s_add_u32 s53, s53, 98304
    s_cmp_eq_u32 s53, 1966080
    s_cselect_b32 s53, 0, s53
    v_mfma_f32_16x16x32_bf16 v[12:15], v[64:67], v[84:87], v[12:15]
    ds_read_b64_tr_b16 v[94:95], v241 offset:12800
    ds_read_b64_tr_b16 v[96:97], v242 offset:12288
    v_mfma_f32_16x16x32_bf16 v[16:19], v[64:67], v[88:91], v[16:19]
    ds_read_b64_tr_b16 v[98:99], v242 offset:12800
    ds_read_b64_tr_b16 v[100:101], v243 offset:12288
    v_mfma_f32_16x16x32_bf16 v[52:55], v[64:67], v[244:247], v[52:55]
    ds_read_b64_tr_b16 v[102:103], v243 offset:12800
    ds_read_b128 v[104:107], v127 offset:8192
    v_mfma_f32_16x16x32_bf16 v[20:23], v[68:71], v[76:79], v[20:23]
    ds_read_b128 v[108:111], v127 offset:10240
    ds_read_b128 v[112:115], v127 offset:12288
    v_mfma_f32_16x16x32_bf16 v[24:27], v[68:71], v[80:83], v[24:27]
    ds_read_b128 v[116:119], v127 offset:14336
    v_mfma_f32_16x16x32_bf16 v[28:31], v[68:71], v[84:87], v[28:31]
    v_mfma_f32_16x16x32_bf16 v[32:35], v[68:71], v[88:91], v[32:35]
    v_mfma_f32_16x16x32_bf16 v[56:59], v[68:71], v[244:247], v[56:59]
    v_mfma_f32_16x16x32_bf16 v[36:39], v[72:75], v[76:79], v[36:39]
    v_mfma_f32_16x16x32_bf16 v[40:43], v[72:75], v[80:83], v[40:43]
    v_mfma_f32_16x16x32_bf16 v[44:47], v[72:75], v[84:87], v[44:47]
    v_mfma_f32_16x16x32_bf16 v[48:51], v[72:75], v[88:91], v[48:51]
    v_mfma_f32_16x16x32_bf16 v[60:63], v[72:75], v[244:247], v[60:63]
    s_waitcnt vmcnt(11) lgkmcnt(0)
    s_barrier
    v_mfma_f32_16x16x32_bf16 v[4:7], v[92:95], v[104:107], v[4:7]
    ds_read_b64_tr_b16 v[64:65], v241 offset:24576
    ds_read_b64_tr_b16 v[66:67], v241 offset:25088
    v_mfma_f32_16x16x32_bf16 v[8:11], v[92:95], v[108:111], v[8:11]
    buffer_load_dwordx2 v[120:121], v254, s[20:23], s65 offen offset:0
    ds_read_b64_tr_b16 v[68:69], v242 offset:24576
    v_mfma_f32_16x16x32_bf16 v[12:15], v[92:95], v[112:115], v[12:15]
    ds_read_b64_tr_b16 v[70:71], v242 offset:25088
    ds_read_b64_tr_b16 v[72:73], v243 offset:24576
    v_mfma_f32_16x16x32_bf16 v[16:19], v[92:95], v[116:119], v[16:19]
    ds_read_b64_tr_b16 v[74:75], v243 offset:25088
    ds_read_b128 v[76:79], v126 offset:16384
    v_mfma_f32_16x16x32_bf16 v[52:55], v[92:95], v[244:247], v[52:55]
    ds_read_b128 v[80:83], v126 offset:18432
    ds_read_b128 v[84:87], v126 offset:20480
    v_mfma_f32_16x16x32_bf16 v[20:23], v[96:99], v[104:107], v[20:23]
    buffer_load_dwordx2 v[122:123], v254, s[20:23], s65 offen offset:32
    ds_read_b128 v[88:91], v126 offset:22528
    v_mfma_f32_16x16x32_bf16 v[24:27], v[96:99], v[108:111], v[24:27]
    v_mfma_f32_16x16x32_bf16 v[28:31], v[96:99], v[112:115], v[28:31]
    v_mfma_f32_16x16x32_bf16 v[32:35], v[96:99], v[116:119], v[32:35]
    v_mfma_f32_16x16x32_bf16 v[56:59], v[96:99], v[244:247], v[56:59]
    v_mfma_f32_16x16x32_bf16 v[36:39], v[100:103], v[104:107], v[36:39]
    buffer_load_dwordx2 v[124:125], v254, s[20:23], s65 offen offset:64
    v_mfma_f32_16x16x32_bf16 v[40:43], v[100:103], v[108:111], v[40:43]
    v_mfma_f32_16x16x32_bf16 v[44:47], v[100:103], v[112:115], v[44:47]
    v_mfma_f32_16x16x32_bf16 v[48:51], v[100:103], v[116:119], v[48:51]
    v_mfma_f32_16x16x32_bf16 v[60:63], v[100:103], v[244:247], v[60:63]
    s_waitcnt vmcnt(11) lgkmcnt(0)
    s_barrier
    v_mfma_f32_16x16x32_bf16 v[4:7], v[64:67], v[76:79], v[4:7]
    ds_read_b64_tr_b16 v[92:93], v241 offset:36864
    ds_read_b64_tr_b16 v[94:95], v241 offset:37376
    v_mfma_f32_16x16x32_bf16 v[8:11], v[64:67], v[80:83], v[8:11]
    ds_read_b64_tr_b16 v[96:97], v242 offset:36864
    ds_read_b64_tr_b16 v[98:99], v242 offset:37376
    v_mfma_f32_16x16x32_bf16 v[12:15], v[64:67], v[84:87], v[12:15]
    ds_read_b64_tr_b16 v[100:101], v243 offset:36864
    ds_read_b64_tr_b16 v[102:103], v243 offset:37376
    v_mfma_f32_16x16x32_bf16 v[16:19], v[64:67], v[88:91], v[16:19]
    ds_read_b128 v[104:107], v127 offset:16384
    ds_read_b128 v[108:111], v127 offset:18432
    v_mfma_f32_16x16x32_bf16 v[52:55], v[64:67], v[244:247], v[52:55]
    ds_read_b128 v[112:115], v127 offset:20480
    ds_read_b128 v[116:119], v127 offset:22528
    v_mfma_f32_16x16x32_bf16 v[20:23], v[68:71], v[76:79], v[20:23]
    v_mfma_f32_16x16x32_bf16 v[24:27], v[68:71], v[80:83], v[24:27]
    v_mfma_f32_16x16x32_bf16 v[28:31], v[68:71], v[84:87], v[28:31]
    v_mfma_f32_16x16x32_bf16 v[32:35], v[68:71], v[88:91], v[32:35]
    v_mfma_f32_16x16x32_bf16 v[56:59], v[68:71], v[244:247], v[56:59]
    v_mfma_f32_16x16x32_bf16 v[36:39], v[72:75], v[76:79], v[36:39]
    v_mfma_f32_16x16x32_bf16 v[40:43], v[72:75], v[80:83], v[40:43]
    v_mfma_f32_16x16x32_bf16 v[44:47], v[72:75], v[84:87], v[44:47]
    v_mfma_f32_16x16x32_bf16 v[48:51], v[72:75], v[88:91], v[48:51]
    v_mfma_f32_16x16x32_bf16 v[60:63], v[72:75], v[244:247], v[60:63]
    s_waitcnt vmcnt(6) lgkmcnt(0)
    s_barrier
    v_mfma_f32_16x16x32_bf16 v[4:7], v[92:95], v[104:107], v[4:7]
    ds_read_b64_tr_b16 v[64:65], v241 offset:49152
    ds_read_b64_tr_b16 v[66:67], v241 offset:49664
    v_mfma_f32_16x16x32_bf16 v[8:11], v[92:95], v[108:111], v[8:11]
    ds_read_b64_tr_b16 v[68:69], v242 offset:49152
    ds_read_b64_tr_b16 v[70:71], v242 offset:49664
    v_mfma_f32_16x16x32_bf16 v[12:15], v[92:95], v[112:115], v[12:15]
    ds_read_b64_tr_b16 v[72:73], v243 offset:49152
    ds_read_b64_tr_b16 v[74:75], v243 offset:49664
    v_mfma_f32_16x16x32_bf16 v[16:19], v[92:95], v[116:119], v[16:19]
    ds_read_b128 v[76:79], v126 offset:0
    ds_read_b128 v[80:83], v126 offset:2048
    v_mfma_f32_16x16x32_bf16 v[52:55], v[92:95], v[244:247], v[52:55]
    ds_read_b128 v[84:87], v126 offset:4096
    ds_read_b128 v[88:91], v126 offset:6144
    v_mfma_f32_16x16x32_bf16 v[20:23], v[96:99], v[104:107], v[20:23]
    v_mfma_f32_16x16x32_bf16 v[24:27], v[96:99], v[108:111], v[24:27]
    v_mfma_f32_16x16x32_bf16 v[28:31], v[96:99], v[112:115], v[28:31]
    v_mfma_f32_16x16x32_bf16 v[32:35], v[96:99], v[116:119], v[32:35]
    v_mfma_f32_16x16x32_bf16 v[56:59], v[96:99], v[244:247], v[56:59]
    v_mfma_f32_16x16x32_bf16 v[36:39], v[100:103], v[104:107], v[36:39]
    v_mfma_f32_16x16x32_bf16 v[40:43], v[100:103], v[108:111], v[40:43]
    v_mfma_f32_16x16x32_bf16 v[44:47], v[100:103], v[112:115], v[44:47]
    v_mfma_f32_16x16x32_bf16 v[48:51], v[100:103], v[116:119], v[48:51]
    v_mfma_f32_16x16x32_bf16 v[60:63], v[100:103], v[244:247], v[60:63]
    s_waitcnt vmcnt(3) lgkmcnt(0)
    s_barrier
    v_mfma_f32_16x16x32_bf16 v[4:7], v[64:67], v[76:79], v[4:7]
    ds_read_b64_tr_b16 v[92:93], v241 offset:61440
    ds_read_b64_tr_b16 v[94:95], v241 offset:61952
    v_mfma_f32_16x16x32_bf16 v[8:11], v[64:67], v[80:83], v[8:11]
    buffer_load_dwordx2 v[232:233], v230, s[12:15], s73 offen offset:0 sc1
    ds_read_b64_tr_b16 v[96:97], v242 offset:61440
    v_mfma_f32_16x16x32_bf16 v[12:15], v[64:67], v[84:87], v[12:15]
    ds_read_b64_tr_b16 v[98:99], v242 offset:61952
    ds_read_b64_tr_b16 v[100:101], v243 offset:61440
    v_mfma_f32_16x16x32_bf16 v[16:19], v[64:67], v[88:91], v[16:19]
    ds_read_b64_tr_b16 v[102:103], v243 offset:61952
    ds_read_b128 v[104:107], v127 offset:0
    v_mfma_f32_16x16x32_bf16 v[52:55], v[64:67], v[244:247], v[52:55]
    buffer_load_dwordx2 v[234:235], v230, s[12:15], s73 offen offset:128 sc1
    ds_read_b128 v[108:111], v127 offset:2048
    v_mfma_f32_16x16x32_bf16 v[20:23], v[68:71], v[76:79], v[20:23]
    ds_read_b128 v[112:115], v127 offset:4096
    ds_read_b128 v[116:119], v127 offset:6144
    v_mfma_f32_16x16x32_bf16 v[24:27], v[68:71], v[80:83], v[24:27]
    v_mfma_f32_16x16x32_bf16 v[28:31], v[68:71], v[84:87], v[28:31]
    v_mfma_f32_16x16x32_bf16 v[32:35], v[68:71], v[88:91], v[32:35]
    buffer_load_dwordx2 v[236:237], v230, s[12:15], s73 offen offset:256 sc1
    v_mfma_f32_16x16x32_bf16 v[56:59], v[68:71], v[244:247], v[56:59]
    v_mfma_f32_16x16x32_bf16 v[36:39], v[72:75], v[76:79], v[36:39]
    v_mfma_f32_16x16x32_bf16 v[40:43], v[72:75], v[80:83], v[40:43]
    buffer_load_dwordx2 v[238:239], v230, s[12:15], s73 offen offset:384 sc1
    v_mfma_f32_16x16x32_bf16 v[44:47], v[72:75], v[84:87], v[44:47]
    v_mfma_f32_16x16x32_bf16 v[48:51], v[72:75], v[88:91], v[48:51]
    v_mfma_f32_16x16x32_bf16 v[60:63], v[72:75], v[244:247], v[60:63]
    s_waitcnt lgkmcnt(0)
    s_barrier
    v_mfma_f32_16x16x32_bf16 v[4:7], v[92:95], v[104:107], v[4:7]
    s_waitcnt vmcnt(6)
    v_lshlrev_b32 v72, 16, v120
    v_and_b32 v73, 0xffff0000, v120
    v_mfma_f32_16x16x32_bf16 v[8:11], v[92:95], v[108:111], v[8:11]
    s_add_u32 s69, s40, 0
    buffer_load_dwordx4 v[128:131], v248, s[12:15], s69 offen offset:0 sc1
    v_mfma_f32_16x16x32_bf16 v[12:15], v[92:95], v[112:115], v[12:15]
    v_lshlrev_b32 v74, 16, v121
    v_and_b32 v75, 0xffff0000, v121
    v_mfma_f32_16x16x32_bf16 v[16:19], v[92:95], v[116:119], v[16:19]
    s_waitcnt vmcnt(6)
    v_lshlrev_b32 v76, 16, v122
    v_and_b32 v77, 0xffff0000, v122
    v_mfma_f32_16x16x32_bf16 v[52:55], v[92:95], v[244:247], v[52:55]
    v_lshlrev_b32 v78, 16, v123
    v_and_b32 v79, 0xffff0000, v123
    v_mfma_f32_16x16x32_bf16 v[20:23], v[96:99], v[104:107], v[20:23]
    buffer_load_dwordx4 v[132:135], v248, s[12:15], s69 offen offset:1024 sc1
    s_waitcnt vmcnt(6)
    v_lshlrev_b32 v80, 16, v124
    v_and_b32 v81, 0xffff0000, v124
    v_mfma_f32_16x16x32_bf16 v[24:27], v[96:99], v[108:111], v[24:27]
    v_lshlrev_b32 v82, 16, v125
    v_and_b32 v83, 0xffff0000, v125
    v_mfma_f32_16x16x32_bf16 v[28:31], v[96:99], v[112:115], v[28:31]
    v_and_b32 v252, 1, v250
    v_lshrrev_b32 v253, 1, v250
    v_mfma_f32_16x16x32_bf16 v[32:35], v[96:99], v[116:119], v[32:35]
    v_lshlrev_b32 v253, 8, v253
    v_lshl_add_u32 v253, v251, 4, v253
    v_mfma_f32_16x16x32_bf16 v[56:59], v[96:99], v[244:247], v[56:59]
    v_lshl_add_u32 v84, v252, 10, v253
    s_mul_i32 s60, s49, 12
    s_mul_i32 s61, s3, 3
    s_add_u32 s60, s60, s61
    s_mul_i32 s66, s48, 196608
    s_add_u32 s66, s66, 0x700000
    v_mfma_f32_16x16x32_bf16 v[36:39], v[100:103], v[104:107], v[36:39]
    buffer_load_dwordx4 v[136:139], v248, s[12:15], s69 offen offset:2048 sc1
    s_add_u32 s61, s60, 0
    s_lshr_b32 s62, s61, 1
    s_lshl_b32 s62, s62, 12
    s_and_b32 s61, s61, 1
    s_lshl_b32 s61, s61, 9
    s_add_u32 s62, s62, s61
    s_add_u32 s63, s62, s66
    v_mfma_f32_16x16x32_bf16 v[40:43], v[100:103], v[108:111], v[40:43]
    s_add_u32 s61, s60, 1
    s_lshr_b32 s62, s61, 1
    s_lshl_b32 s62, s62, 12
    s_and_b32 s61, s61, 1
    s_lshl_b32 s61, s61, 9
    s_add_u32 s62, s62, s61
    s_add_u32 s64, s62, s66
    v_mfma_f32_16x16x32_bf16 v[44:47], v[100:103], v[112:115], v[44:47]
    s_add_u32 s61, s60, 2
    s_lshr_b32 s62, s61, 1
    s_lshl_b32 s62, s62, 12
    s_and_b32 s61, s61, 1
    s_lshl_b32 s61, s61, 9
    s_add_u32 s62, s62, s61
    s_add_u32 s65, s62, s66
    v_mfma_f32_16x16x32_bf16 v[48:51], v[100:103], v[116:119], v[48:51]
    s_mov_b32 s60, 0xbdd2d3e8
    s_mov_b32 s61, 0xc0135761
    v_mov_b32 v85, s61
    v_mfma_f32_16x16x32_bf16 v[60:63], v[100:103], v[244:247], v[60:63]
    s_waitcnt vmcnt(6)
    v_pk_fma_f32 v[64:65], v[232:233], v[52:53], v[72:73] op_sel:[1,0,0] op_sel_hi:[1,1,1]
    v_pk_fma_f32 v[66:67], v[232:233], v[54:55], v[74:75] op_sel:[1,0,0] op_sel_hi:[1,1,1]
    v_pk_fma_f32 v[64:65], v[4:5], v[232:233], v[64:65] op_sel_hi:[1,0,1]
    v_pk_fma_f32 v[66:67], v[6:7], v[232:233], v[66:67] op_sel_hi:[1,0,1]
    v_pk_mul_f32 v[68:69], v[64:65], v[64:65]
    v_pk_mul_f32 v[70:71], v[66:67], v[66:67]
    v_pk_fma_f32 v[68:69], v[68:69], s[60:61], s[60:61] op_sel:[0,0,1] op_sel_hi:[1,0,1]
    v_pk_fma_f32 v[70:71], v[70:71], s[60:61], s[60:61] op_sel:[0,0,1] op_sel_hi:[1,0,1]
    v_pk_mul_f32 v[68:69], v[68:69], v[64:65]
    v_pk_mul_f32 v[70:71], v[70:71], v[66:67]
    v_exp_f32 v68, v68
    v_exp_f32 v69, v69
    v_exp_f32 v70, v70
    v_exp_f32 v71, v71
    buffer_load_dwordx4 v[140:143], v248, s[12:15], s69 offen offset:3072 sc1
    v_pk_add_f32 v[68:69], v[68:69], 1.0 op_sel_hi:[1,0]
    v_pk_add_f32 v[70:71], v[70:71], 1.0 op_sel_hi:[1,0]
    v_rcp_f32 v68, v68
    v_rcp_f32 v69, v69
    v_rcp_f32 v70, v70
    v_rcp_f32 v71, v71
    v_pk_mul_f32 v[64:65], v[64:65], v[68:69]
    v_pk_mul_f32 v[66:67], v[66:67], v[70:71]
    v_cvt_pk_bf16_f32 v88, v64, v65
    v_cvt_pk_bf16_f32 v89, v66, v67
    s_waitcnt vmcnt(6)
    v_pk_fma_f32 v[64:65], v[234:235], v[52:53], v[72:73] op_sel:[1,0,0] op_sel_hi:[1,1,1]
    v_pk_fma_f32 v[66:67], v[234:235], v[54:55], v[74:75] op_sel:[1,0,0] op_sel_hi:[1,1,1]
    v_pk_fma_f32 v[64:65], v[8:9], v[234:235], v[64:65] op_sel_hi:[1,0,1]
    v_pk_fma_f32 v[66:67], v[10:11], v[234:235], v[66:67] op_sel_hi:[1,0,1]
    v_pk_mul_f32 v[68:69], v[64:65], v[64:65]
    v_pk_mul_f32 v[70:71], v[66:67], v[66:67]
    v_pk_fma_f32 v[68:69], v[68:69], s[60:61], s[60:61] op_sel:[0,0,1] op_sel_hi:[1,0,1]
    v_pk_fma_f32 v[70:71], v[70:71], s[60:61], s[60:61] op_sel:[0,0,1] op_sel_hi:[1,0,1]
    v_pk_mul_f32 v[68:69], v[68:69], v[64:65]
    v_pk_mul_f32 v[70:71], v[70:71], v[66:67]
    v_exp_f32 v68, v68
    v_exp_f32 v69, v69
    v_exp_f32 v70, v70
    v_exp_f32 v71, v71
    buffer_load_dwordx4 v[144:147], v249, s[12:15], s69 offen sc1
    v_pk_add_f32 v[68:69], v[68:69], 1.0 op_sel_hi:[1,0]
    v_pk_add_f32 v[70:71], v[70:71], 1.0 op_sel_hi:[1,0]
    v_rcp_f32 v68, v68
    v_rcp_f32 v69, v69
    v_rcp_f32 v70, v70
    v_rcp_f32 v71, v71
    v_pk_mul_f32 v[64:65], v[64:65], v[68:69]
    v_pk_mul_f32 v[66:67], v[66:67], v[70:71]
    v_cvt_pk_bf16_f32 v90, v64, v65
    v_cvt_pk_bf16_f32 v91, v66, v67
    s_nop 0
    v_permlane16_swap_b32 v88, v90
    v_permlane16_swap_b32 v89, v91
    buffer_store_dwordx4 v[88:91], v84, s[12:15], s63 offen offset:0 sc1
    s_waitcnt vmcnt(7)
    v_pk_fma_f32 v[64:65], v[236:237], v[52:53], v[72:73] op_sel:[1,0,0] op_sel_hi:[1,1,1]
    v_pk_fma_f32 v[66:67], v[236:237], v[54:55], v[74:75] op_sel:[1,0,0] op_sel_hi:[1,1,1]
    v_pk_fma_f32 v[64:65], v[12:13], v[236:237], v[64:65] op_sel_hi:[1,0,1]
    v_pk_fma_f32 v[66:67], v[14:15], v[236:237], v[66:67] op_sel_hi:[1,0,1]
    v_pk_mul_f32 v[68:69], v[64:65], v[64:65]
    v_pk_mul_f32 v[70:71], v[66:67], v[66:67]
    v_pk_fma_f32 v[68:69], v[68:69], s[60:61], s[60:61] op_sel:[0,0,1] op_sel_hi:[1,0,1]
    v_pk_fma_f32 v[70:71], v[70:71], s[60:61], s[60:61] op_sel:[0,0,1] op_sel_hi:[1,0,1]
    v_pk_mul_f32 v[68:69], v[68:69], v[64:65]
    v_pk_mul_f32 v[70:71], v[70:71], v[66:67]
    v_exp_f32 v68, v68
    v_exp_f32 v69, v69
    v_exp_f32 v70, v70
    v_exp_f32 v71, v71
    s_add_u32 s69, s40, 5120
    buffer_load_dwordx4 v[148:151], v248, s[12:15], s69 offen offset:0 sc1
    v_pk_add_f32 v[68:69], v[68:69], 1.0 op_sel_hi:[1,0]
    v_pk_add_f32 v[70:71], v[70:71], 1.0 op_sel_hi:[1,0]
    v_rcp_f32 v68, v68
    v_rcp_f32 v69, v69
    v_rcp_f32 v70, v70
    v_rcp_f32 v71, v71
    v_pk_mul_f32 v[64:65], v[64:65], v[68:69]
    v_pk_mul_f32 v[66:67], v[66:67], v[70:71]
    v_cvt_pk_bf16_f32 v92, v64, v65
    v_cvt_pk_bf16_f32 v93, v66, v67
    s_waitcnt vmcnt(7)
    v_pk_fma_f32 v[64:65], v[238:239], v[52:53], v[72:73] op_sel:[1,0,0] op_sel_hi:[1,1,1]
    v_pk_fma_f32 v[66:67], v[238:239], v[54:55], v[74:75] op_sel:[1,0,0] op_sel_hi:[1,1,1]
    v_pk_fma_f32 v[64:65], v[16:17], v[238:239], v[64:65] op_sel_hi:[1,0,1]
    v_pk_fma_f32 v[66:67], v[18:19], v[238:239], v[66:67] op_sel_hi:[1,0,1]
    v_pk_mul_f32 v[68:69], v[64:65], v[64:65]
    v_pk_mul_f32 v[70:71], v[66:67], v[66:67]
    v_pk_fma_f32 v[68:69], v[68:69], s[60:61], s[60:61] op_sel:[0,0,1] op_sel_hi:[1,0,1]
    v_pk_fma_f32 v[70:71], v[70:71], s[60:61], s[60:61] op_sel:[0,0,1] op_sel_hi:[1,0,1]
    v_pk_mul_f32 v[68:69], v[68:69], v[64:65]
    v_pk_mul_f32 v[70:71], v[70:71], v[66:67]
    v_exp_f32 v68, v68
    v_exp_f32 v69, v69
    v_exp_f32 v70, v70
    v_exp_f32 v71, v71
    buffer_load_dwordx4 v[152:155], v248, s[12:15], s69 offen offset:1024 sc1
    v_pk_add_f32 v[68:69], v[68:69], 1.0 op_sel_hi:[1,0]
    v_pk_add_f32 v[70:71], v[70:71], 1.0 op_sel_hi:[1,0]
    v_rcp_f32 v68, v68
    v_rcp_f32 v69, v69
    v_rcp_f32 v70, v70
    v_rcp_f32 v71, v71
    v_pk_mul_f32 v[64:65], v[64:65], v[68:69]
    v_pk_mul_f32 v[66:67], v[66:67], v[70:71]
    v_cvt_pk_bf16_f32 v94, v64, v65
    v_cvt_pk_bf16_f32 v95, v66, v67
    s_nop 0
    v_permlane16_swap_b32 v92, v94
    v_permlane16_swap_b32 v93, v95
    buffer_store_dwordx4 v[92:95], v84, s[12:15], s63 offen offset:2048 sc1
    v_pk_fma_f32 v[64:65], v[232:233], v[56:57], v[76:77] op_sel:[1,0,0] op_sel_hi:[1,1,1]
    v_pk_fma_f32 v[66:67], v[232:233], v[58:59], v[78:79] op_sel:[1,0,0] op_sel_hi:[1,1,1]
    v_pk_fma_f32 v[64:65], v[20:21], v[232:233], v[64:65] op_sel_hi:[1,0,1]
    v_pk_fma_f32 v[66:67], v[22:23], v[232:233], v[66:67] op_sel_hi:[1,0,1]
    v_pk_mul_f32 v[68:69], v[64:65], v[64:65]
    v_pk_mul_f32 v[70:71], v[66:67], v[66:67]
    v_pk_fma_f32 v[68:69], v[68:69], s[60:61], s[60:61] op_sel:[0,0,1] op_sel_hi:[1,0,1]
    v_pk_fma_f32 v[70:71], v[70:71], s[60:61], s[60:61] op_sel:[0,0,1] op_sel_hi:[1,0,1]
    v_pk_mul_f32 v[68:69], v[68:69], v[64:65]
    v_pk_mul_f32 v[70:71], v[70:71], v[66:67]
    v_exp_f32 v68, v68
    v_exp_f32 v69, v69
    v_exp_f32 v70, v70
    v_exp_f32 v71, v71
    buffer_load_dwordx4 v[156:159], v248, s[12:15], s69 offen offset:2048 sc1
    v_pk_add_f32 v[68:69], v[68:69], 1.0 op_sel_hi:[1,0]
    v_pk_add_f32 v[70:71], v[70:71], 1.0 op_sel_hi:[1,0]
    v_rcp_f32 v68, v68
    v_rcp_f32 v69, v69
    v_rcp_f32 v70, v70
    v_rcp_f32 v71, v71
    v_pk_mul_f32 v[64:65], v[64:65], v[68:69]
    v_pk_mul_f32 v[66:67], v[66:67], v[70:71]
    v_cvt_pk_bf16_f32 v88, v64, v65
    v_cvt_pk_bf16_f32 v89, v66, v67
    v_pk_fma_f32 v[64:65], v[234:235], v[56:57], v[76:77] op_sel:[1,0,0] op_sel_hi:[1,1,1]
    v_pk_fma_f32 v[66:67], v[234:235], v[58:59], v[78:79] op_sel:[1,0,0] op_sel_hi:[1,1,1]
    v_pk_fma_f32 v[64:65], v[24:25], v[234:235], v[64:65] op_sel_hi:[1,0,1]
    v_pk_fma_f32 v[66:67], v[26:27], v[234:235], v[66:67] op_sel_hi:[1,0,1]
    v_pk_mul_f32 v[68:69], v[64:65], v[64:65]
    v_pk_mul_f32 v[70:71], v[66:67], v[66:67]
    v_pk_fma_f32 v[68:69], v[68:69], s[60:61], s[60:61] op_sel:[0,0,1] op_sel_hi:[1,0,1]
    v_pk_fma_f32 v[70:71], v[70:71], s[60:61], s[60:61] op_sel:[0,0,1] op_sel_hi:[1,0,1]
    v_pk_mul_f32 v[68:69], v[68:69], v[64:65]
    v_pk_mul_f32 v[70:71], v[70:71], v[66:67]
    v_exp_f32 v68, v68
    v_exp_f32 v69, v69
    v_exp_f32 v70, v70
    v_exp_f32 v71, v71
    buffer_load_dwordx4 v[160:163], v248, s[12:15], s69 offen offset:3072 sc1
    v_pk_add_f32 v[68:69], v[68:69], 1.0 op_sel_hi:[1,0]
    v_pk_add_f32 v[70:71], v[70:71], 1.0 op_sel_hi:[1,0]
    v_rcp_f32 v68, v68
    v_rcp_f32 v69, v69
    v_rcp_f32 v70, v70
    v_rcp_f32 v71, v71
    v_pk_mul_f32 v[64:65], v[64:65], v[68:69]
    v_pk_mul_f32 v[66:67], v[66:67], v[70:71]
    v_cvt_pk_bf16_f32 v90, v64, v65
    v_cvt_pk_bf16_f32 v91, v66, v67
    s_nop 0
    v_permlane16_swap_b32 v88, v90
    v_permlane16_swap_b32 v89, v91
    buffer_store_dwordx4 v[88:91], v84, s[12:15], s64 offen offset:0 sc1
    v_pk_fma_f32 v[64:65], v[236:237], v[56:57], v[76:77] op_sel:[1,0,0] op_sel_hi:[1,1,1]
    v_pk_fma_f32 v[66:67], v[236:237], v[58:59], v[78:79] op_sel:[1,0,0] op_sel_hi:[1,1,1]
    v_pk_fma_f32 v[64:65], v[28:29], v[236:237], v[64:65] op_sel_hi:[1,0,1]
    v_pk_fma_f32 v[66:67], v[30:31], v[236:237], v[66:67] op_sel_hi:[1,0,1]
    v_pk_mul_f32 v[68:69], v[64:65], v[64:65]
    v_pk_mul_f32 v[70:71], v[66:67], v[66:67]
    v_pk_fma_f32 v[68:69], v[68:69], s[60:61], s[60:61] op_sel:[0,0,1] op_sel_hi:[1,0,1]
    v_pk_fma_f32 v[70:71], v[70:71], s[60:61], s[60:61] op_sel:[0,0,1] op_sel_hi:[1,0,1]
    v_pk_mul_f32 v[68:69], v[68:69], v[64:65]
    v_pk_mul_f32 v[70:71], v[70:71], v[66:67]
    v_exp_f32 v68, v68
    v_exp_f32 v69, v69
    v_exp_f32 v70, v70
    v_exp_f32 v71, v71
    buffer_load_dwordx4 v[164:167], v249, s[12:15], s69 offen sc1
    v_pk_add_f32 v[68:69], v[68:69], 1.0 op_sel_hi:[1,0]
    v_pk_add_f32 v[70:71], v[70:71], 1.0 op_sel_hi:[1,0]
    v_rcp_f32 v68, v68
    v_rcp_f32 v69, v69
    v_rcp_f32 v70, v70
    v_rcp_f32 v71, v71
    v_pk_mul_f32 v[64:65], v[64:65], v[68:69]
    v_pk_mul_f32 v[66:67], v[66:67], v[70:71]
    v_cvt_pk_bf16_f32 v92, v64, v65
    v_cvt_pk_bf16_f32 v93, v66, v67
    v_pk_fma_f32 v[64:65], v[238:239], v[56:57], v[76:77] op_sel:[1,0,0] op_sel_hi:[1,1,1]
    v_pk_fma_f32 v[66:67], v[238:239], v[58:59], v[78:79] op_sel:[1,0,0] op_sel_hi:[1,1,1]
    v_pk_fma_f32 v[64:65], v[32:33], v[238:239], v[64:65] op_sel_hi:[1,0,1]
    v_pk_fma_f32 v[66:67], v[34:35], v[238:239], v[66:67] op_sel_hi:[1,0,1]
    v_pk_mul_f32 v[68:69], v[64:65], v[64:65]
    v_pk_mul_f32 v[70:71], v[66:67], v[66:67]
    v_pk_fma_f32 v[68:69], v[68:69], s[60:61], s[60:61] op_sel:[0,0,1] op_sel_hi:[1,0,1]
    v_pk_fma_f32 v[70:71], v[70:71], s[60:61], s[60:61] op_sel:[0,0,1] op_sel_hi:[1,0,1]
    v_pk_mul_f32 v[68:69], v[68:69], v[64:65]
    v_pk_mul_f32 v[70:71], v[70:71], v[66:67]
    v_exp_f32 v68, v68
    v_exp_f32 v69, v69
    v_exp_f32 v70, v70
    v_exp_f32 v71, v71
    s_add_u32 s69, s40, 10240
    buffer_load_dwordx4 v[168:171], v248, s[12:15], s69 offen offset:0 sc1
    v_pk_add_f32 v[68:69], v[68:69], 1.0 op_sel_hi:[1,0]
    v_pk_add_f32 v[70:71], v[70:71], 1.0 op_sel_hi:[1,0]
    v_rcp_f32 v68, v68
    v_rcp_f32 v69, v69
    v_rcp_f32 v70, v70
    v_rcp_f32 v71, v71
    v_pk_mul_f32 v[64:65], v[64:65], v[68:69]
    v_pk_mul_f32 v[66:67], v[66:67], v[70:71]
    v_cvt_pk_bf16_f32 v94, v64, v65
    v_cvt_pk_bf16_f32 v95, v66, v67
    s_nop 0
    v_permlane16_swap_b32 v92, v94
    v_permlane16_swap_b32 v93, v95
    buffer_store_dwordx4 v[92:95], v84, s[12:15], s64 offen offset:2048 sc1
    v_pk_fma_f32 v[64:65], v[232:233], v[60:61], v[80:81] op_sel:[1,0,0] op_sel_hi:[1,1,1]
    v_pk_fma_f32 v[66:67], v[232:233], v[62:63], v[82:83] op_sel:[1,0,0] op_sel_hi:[1,1,1]
    v_pk_fma_f32 v[64:65], v[36:37], v[232:233], v[64:65] op_sel_hi:[1,0,1]
    v_pk_fma_f32 v[66:67], v[38:39], v[232:233], v[66:67] op_sel_hi:[1,0,1]
    v_pk_mul_f32 v[68:69], v[64:65], v[64:65]
    v_pk_mul_f32 v[70:71], v[66:67], v[66:67]
    v_pk_fma_f32 v[68:69], v[68:69], s[60:61], s[60:61] op_sel:[0,0,1] op_sel_hi:[1,0,1]
    v_pk_fma_f32 v[70:71], v[70:71], s[60:61], s[60:61] op_sel:[0,0,1] op_sel_hi:[1,0,1]
    v_pk_mul_f32 v[68:69], v[68:69], v[64:65]
    v_pk_mul_f32 v[70:71], v[70:71], v[66:67]
    v_exp_f32 v68, v68
    v_exp_f32 v69, v69
    v_exp_f32 v70, v70
    v_exp_f32 v71, v71
    buffer_load_dwordx4 v[172:175], v248, s[12:15], s69 offen offset:1024 sc1
    v_pk_add_f32 v[68:69], v[68:69], 1.0 op_sel_hi:[1,0]
    v_pk_add_f32 v[70:71], v[70:71], 1.0 op_sel_hi:[1,0]
    v_rcp_f32 v68, v68
    v_rcp_f32 v69, v69
    v_rcp_f32 v70, v70
    v_rcp_f32 v71, v71
    v_pk_mul_f32 v[64:65], v[64:65], v[68:69]
    v_pk_mul_f32 v[66:67], v[66:67], v[70:71]
    v_cvt_pk_bf16_f32 v88, v64, v65
    v_cvt_pk_bf16_f32 v89, v66, v67
    v_pk_fma_f32 v[64:65], v[234:235], v[60:61], v[80:81] op_sel:[1,0,0] op_sel_hi:[1,1,1]
    v_pk_fma_f32 v[66:67], v[234:235], v[62:63], v[82:83] op_sel:[1,0,0] op_sel_hi:[1,1,1]
    v_pk_fma_f32 v[64:65], v[40:41], v[234:235], v[64:65] op_sel_hi:[1,0,1]
    v_pk_fma_f32 v[66:67], v[42:43], v[234:235], v[66:67] op_sel_hi:[1,0,1]
    v_pk_mul_f32 v[68:69], v[64:65], v[64:65]
    v_pk_mul_f32 v[70:71], v[66:67], v[66:67]
    v_pk_fma_f32 v[68:69], v[68:69], s[60:61], s[60:61] op_sel:[0,0,1] op_sel_hi:[1,0,1]
    v_pk_fma_f32 v[70:71], v[70:71], s[60:61], s[60:61] op_sel:[0,0,1] op_sel_hi:[1,0,1]
    v_pk_mul_f32 v[68:69], v[68:69], v[64:65]
    v_pk_mul_f32 v[70:71], v[70:71], v[66:67]
    v_exp_f32 v68, v68
    v_exp_f32 v69, v69
    v_exp_f32 v70, v70
    v_exp_f32 v71, v71
    buffer_load_dwordx4 v[176:179], v248, s[12:15], s69 offen offset:2048 sc1
    v_pk_add_f32 v[68:69], v[68:69], 1.0 op_sel_hi:[1,0]
    v_pk_add_f32 v[70:71], v[70:71], 1.0 op_sel_hi:[1,0]
    v_rcp_f32 v68, v68
    v_rcp_f32 v69, v69
    v_rcp_f32 v70, v70
    v_rcp_f32 v71, v71
    v_pk_mul_f32 v[64:65], v[64:65], v[68:69]
    v_pk_mul_f32 v[66:67], v[66:67], v[70:71]
    s_mov_b64 exec, 1
    ds_add_u32 v228, v229 offset:32
    s_mov_b64 exec, -1
    v_cvt_pk_bf16_f32 v90, v64, v65
    v_cvt_pk_bf16_f32 v91, v66, v67
    s_nop 0
    v_permlane16_swap_b32 v88, v90
    v_permlane16_swap_b32 v89, v91
    buffer_store_dwordx4 v[88:91], v84, s[12:15], s65 offen offset:0 sc1
    v_fma_f32 v64, v60, v237, v80
    v_fma_f32 v65, v61, v237, v81
    v_fma_f32 v66, v62, v237, v82
    v_fma_f32 v67, v63, v237, v83
    v_fmac_f32 v64, v44, v236
    v_fmac_f32 v65, v45, v236
    v_fmac_f32 v66, v46, v236
    v_fmac_f32 v67, v47, v236
    v_mul_f32 v68, v64, v64
    v_mul_f32 v69, v65, v65
    v_mul_f32 v70, v66, v66
    v_mul_f32 v71, v67, v67
    v_fma_f32 v68, v68, s60, v85
    v_fma_f32 v69, v69, s60, v85
    v_fma_f32 v70, v70, s60, v85
    v_fma_f32 v71, v71, s60, v85
    v_mul_f32 v68, v68, v64
    v_mul_f32 v69, v69, v65
    v_mul_f32 v70, v70, v66
    v_mul_f32 v71, v71, v67
    v_exp_f32 v68, v68
    v_exp_f32 v69, v69
    v_exp_f32 v70, v70
    v_exp_f32 v71, v71
    v_add_f32 v68, 1.0, v68
    v_add_f32 v69, 1.0, v69
    v_add_f32 v70, 1.0, v70
    v_add_f32 v71, 1.0, v71
    v_rcp_f32 v68, v68
    v_rcp_f32 v69, v69
    v_rcp_f32 v70, v70
    v_rcp_f32 v71, v71
    buffer_load_dwordx4 v[180:183], v248, s[12:15], s69 offen offset:3072 sc1
    v_mul_f32 v64, v64, v68
    v_mul_f32 v65, v65, v69
    v_mul_f32 v66, v66, v70
    v_mul_f32 v67, v67, v71
    v_cvt_pk_bf16_f32 v92, v64, v65
    v_cvt_pk_bf16_f32 v93, v66, v67
    v_fma_f32 v64, v60, v239, v80
    v_fma_f32 v65, v61, v239, v81
    v_fma_f32 v66, v62, v239, v82
    v_fma_f32 v67, v63, v239, v83
    v_fmac_f32 v64, v48, v238
    v_fmac_f32 v65, v49, v238
    v_fmac_f32 v66, v50, v238
    v_fmac_f32 v67, v51, v238
    v_mul_f32 v68, v64, v64
    v_mul_f32 v69, v65, v65
    v_mul_f32 v70, v66, v66
    v_mul_f32 v71, v67, v67
    v_fma_f32 v68, v68, s60, v85
    v_fma_f32 v69, v69, s60, v85
    v_fma_f32 v70, v70, s60, v85
    v_fma_f32 v71, v71, s60, v85
    v_mul_f32 v68, v68, v64
    v_mul_f32 v69, v69, v65
    v_mul_f32 v70, v70, v66
    v_mul_f32 v71, v71, v67
    v_exp_f32 v68, v68
    v_exp_f32 v69, v69
    v_exp_f32 v70, v70
    v_exp_f32 v71, v71
    v_add_f32 v68, 1.0, v68
    v_add_f32 v69, 1.0, v69
    v_add_f32 v70, 1.0, v70
    v_add_f32 v71, 1.0, v71
    v_rcp_f32 v68, v68
    v_rcp_f32 v69, v69
    v_rcp_f32 v70, v70
    v_rcp_f32 v71, v71
    buffer_load_dwordx4 v[184:187], v249, s[12:15], s69 offen sc1
    v_mul_f32 v64, v64, v68
    v_mul_f32 v65, v65, v69
    v_mul_f32 v66, v66, v70
    v_mul_f32 v67, v67, v71
    v_cvt_pk_bf16_f32 v94, v64, v65
    v_cvt_pk_bf16_f32 v95, v66, v67
    s_nop 0
    v_permlane16_swap_b32 v92, v94
    v_permlane16_swap_b32 v93, v95
    buffer_store_dwordx4 v[92:95], v84, s[12:15], s65 offen offset:2048 sc1
    v_mul_u32_u24 v253, 336, v251
    v_lshl_add_u32 v253, v250, 4, v253
    v_add_u32 v252, s68, v253
    v_add_u32 v250, s67, v248
    v_add_u32 v251, s68, v248
    v_lshlrev_b32 v1, 9, v0
    v_mov_b32 v253, 3584
    v_mov_b32 v254, 1
    s_lshl_b32 s66, s48, 12
    s_lshr_b32 s60, s49, 1
    s_lshl_b32 s60, s60, 7
    s_add_u32 s66, s66, s60
    s_and_b32 s60, s49, 1
    s_lshl2_add_u32 s66, s60, s66
    s_add_u32 s66, s66, 0xd40000
    s_add_u32 s16, s44, 0
    s_add_u32 s17, s44, 4096
    s_add_u32 s18, s44, 8192
    s_add_u32 s19, s45, 0
    s_add_u32 s20, s45, 4096
    s_add_u32 s21, s45, 8192
    s_add_u32 s22, s46, 0
    s_add_u32 s23, s46, 4096
    s_add_u32 s24, s46, 8192
    s_add_u32 s25, s47, 0
    s_add_u32 s26, s47, 4096
    s_add_u32 s27, s47, 8192
    s_add_u32 s69, s41, 0
    buffer_load_dwordx4 v[188:191], v248, s[12:15], s69 offen offset:0 sc1
    buffer_load_dwordx4 v[192:195], v248, s[12:15], s69 offen offset:1024 sc1
    buffer_load_dwordx4 v[196:199], v248, s[12:15], s69 offen offset:2048 sc1
    buffer_load_dwordx4 v[200:203], v248, s[12:15], s69 offen offset:3072 sc1
    buffer_load_dwordx4 v[204:207], v249, s[12:15], s69 offen sc1
    s_waitcnt vmcnt(5)
    s_mov_b64 exec, 1
    ds_add_rtn_u32 v0, v253, v254 offset:0
    s_waitcnt lgkmcnt(0)
    v_readfirstlane_b32 s60, v0
    s_mov_b64 exec, -1
    s_cmp_eq_u32 s60, 3
    s_cbranch_scc0 hs_37
    s_mov_b64 exec, 0xff
    buffer_store_dword v254, v1, s[12:15], s66 offen sc1
    s_mov_b64 exec, -1
hs_37:
    s_add_u32 s69, s41, 5120
    buffer_load_dwordx4 v[208:211], v248, s[12:15], s69 offen offset:0 sc1
    buffer_load_dwordx4 v[212:215], v248, s[12:15], s69 offen offset:1024 sc1
    buffer_load_dwordx4 v[216:219], v248, s[12:15], s69 offen offset:2048 sc1
    buffer_load_dwordx4 v[220:223], v248, s[12:15], s69 offen offset:3072 sc1
    buffer_load_dwordx4 v[224:227], v249, s[12:15], s69 offen sc1
    s_add_u32 s69, s41, 10240
    buffer_load_dwordx4 v[228:231], v248, s[12:15], s69 offen offset:0 sc1
    buffer_load_dwordx4 v[232:235], v248, s[12:15], s69 offen offset:1024 sc1
    buffer_load_dwordx4 v[236:239], v248, s[12:15], s69 offen offset:2048 sc1
    buffer_load_dwordx4 v[240:243], v248, s[12:15], s69 offen offset:3072 sc1
    buffer_load_dwordx4 v[244:247], v249, s[12:15], s69 offen sc1
    s_cmp_ge_u32 s2, 160
    s_cbranch_scc1 c_nd1
    s_mov_b32 s76, 0
    s_branch lw_38f
lw_38:
    s_sleep 1
    s_add_u32 s76, s76, 1
    s_cmp_gt_u32 s76, 1600000
    s_cbranch_scc1 lx_39
lw_38f:
    ds_read_b32 v0, v253 offset:12
    s_waitcnt lgkmcnt(0)
    v_readfirstlane_b32 s60, v0
    s_cmp_lt_u32 s60, 4
    s_cbranch_scc1 lw_38
lx_39:
    s_add_u32 s69, s42, 0
    s_add_u32 m0, s67, 0
    s_nop 0
    buffer_load_dwordx4 v248, s[12:15], s69 offen sc1 lds
    buffer_load_dwordx4 v248, s[12:15], s69 offen offset:1024 sc1 lds
    buffer_load_dwordx4 v248, s[12:15], s69 offen offset:2048 sc1 lds
    buffer_load_dwordx4 v248, s[12:15], s69 offen offset:3072 sc1 lds
    s_add_u32 m0, s67, 4096
    s_nop 0
    buffer_load_dwordx4 v249, s[12:15], s69 offen sc1 lds
    s_add_u32 s69, s42, 5120
    s_add_u32 m0, s67, 5120
    s_nop 0
    buffer_load_dwordx4 v248, s[12:15], s69 offen sc1 lds
    buffer_load_dwordx4 v248, s[12:15], s69 offen offset:1024 sc1 lds
    buffer_load_dwordx4 v248, s[12:15], s69 offen offset:2048 sc1 lds
    buffer_load_dwordx4 v248, s[12:15], s69 offen offset:3072 sc1 lds
    s_add_u32 m0, s67, 9216
    s_nop 0
    buffer_load_dwordx4 v249, s[12:15], s69 offen sc1 lds
c_nd1:
    s_mov_b32 s76, 0
    s_branch HF_40f
HF_40:
    s_sleep 2
    s_add_u32 s76, s76, 1
    s_cmp_gt_u32 s76, 200000
    s_cbranch_scc1 HFx_41
HF_40f:
    s_load_dwordx2 s[62:63], s[12:13], s74 glc
    s_waitcnt lgkmcnt(0)
    s_and_b32 s62, s62, s63
    s_cmp_eq_u32 s62, 1
    s_cbranch_scc0 HF_40
HFx_41:
    buffer_load_dwordx4 v[80:83], v248, s[12:15], s16 offen offset:0 sc1
    buffer_load_dwordx4 v[84:87], v248, s[12:15], s16 offen offset:1024 sc1
    buffer_load_dwordx4 v[88:91], v248, s[12:15], s16 offen offset:2048 sc1
    buffer_load_dwordx4 v[92:95], v248, s[12:15], s16 offen offset:3072 sc1
    buffer_load_dwordx4 v[96:99], v248, s[12:15], s17 offen offset:0 sc1
    buffer_load_dwordx4 v[100:103], v248, s[12:15], s17 offen offset:1024 sc1
    buffer_load_dwordx4 v[104:107], v248, s[12:15], s17 offen offset:2048 sc1
    buffer_load_dwordx4 v[108:111], v248, s[12:15], s17 offen offset:3072 sc1
    buffer_load_dwordx4 v[112:115], v248, s[12:15], s18 offen offset:0 sc1
    buffer_load_dwordx4 v[116:119], v248, s[12:15], s18 offen offset:1024 sc1
    buffer_load_dwordx4 v[120:123], v248, s[12:15], s18 offen offset:2048 sc1
    buffer_load_dwordx4 v[124:127], v248, s[12:15], s18 offen offset:3072 sc1
    s_cmp_ge_u32 s2, 160
    s_cbranch_scc1 c_nd2
    s_add_u32 s69, s42, 10240
    s_add_u32 m0, s68, 0
    s_nop 0
    buffer_load_dwordx4 v248, s[12:15], s69 offen sc1 lds
    buffer_load_dwordx4 v248, s[12:15], s69 offen offset:1024 sc1 lds
    buffer_load_dwordx4 v248, s[12:15], s69 offen offset:2048 sc1 lds
    buffer_load_dwordx4 v248, s[12:15], s69 offen offset:3072 sc1 lds
    s_add_u32 m0, s68, 4096
    s_nop 0
    buffer_load_dwordx4 v249, s[12:15], s69 offen sc1 lds
    s_add_u32 s69, s43, 0
    s_add_u32 m0, s68, 5120
    s_nop 0
    buffer_load_dwordx4 v248, s[12:15], s69 offen sc1 lds
    buffer_load_dwordx4 v248, s[12:15], s69 offen offset:1024 sc1 lds
    buffer_load_dwordx4 v248, s[12:15], s69 offen offset:2048 sc1 lds
    buffer_load_dwordx4 v248, s[12:15], s69 offen offset:3072 sc1 lds
    s_add_u32 m0, s68, 9216
    s_nop 0
    buffer_load_dwordx4 v249, s[12:15], s69 offen sc1 lds
    s_add_u32 s69, s43, 5120
    s_add_u32 m0, s68, 10240
    s_nop 0
    buffer_load_dwordx4 v248, s[12:15], s69 offen sc1 lds
    buffer_load_dwordx4 v248, s[12:15], s69 offen offset:1024 sc1 lds
    buffer_load_dwordx4 v248, s[12:15], s69 offen offset:2048 sc1 lds
    buffer_load_dwordx4 v248, s[12:15], s69 offen offset:3072 sc1 lds
    s_add_u32 m0, s68, 14336
    s_nop 0
    buffer_load_dwordx4 v249, s[12:15], s69 offen sc1 lds
c_nd2:
    s_waitcnt vmcnt(11)
    v_mfma_f32_16x16x32_bf16 v[0:3], v[128:131], v[80:83], 0
    v_mfma_f32_16x16x32_bf16 v[4:7], v[132:135], v[80:83], 0
    s_add_u32 s69, s43, 10240
    s_add_u32 m0, s68, 15360
    s_nop 0
    buffer_load_dwordx4 v248, s[12:15], s69 offen sc1 lds
    v_mfma_f32_16x16x32_bf16 v[8:11], v[136:139], v[80:83], 0
    v_mfma_f32_16x16x32_bf16 v[12:15], v[140:143], v[80:83], 0
    v_mfma_f32_16x16x32_bf16 v[16:19], v[144:147], v[80:83], 0
    s_waitcnt vmcnt(11)
    v_mfma_f32_16x16x32_bf16 v[20:23], v[128:131], v[84:87], 0
    buffer_load_dwordx4 v248, s[12:15], s69 offen offset:1024 sc1 lds
    v_mfma_f32_16x16x32_bf16 v[24:27], v[132:135], v[84:87], 0
    v_mfma_f32_16x16x32_bf16 v[28:31], v[136:139], v[84:87], 0
    v_mfma_f32_16x16x32_bf16 v[32:35], v[140:143], v[84:87], 0
    v_mfma_f32_16x16x32_bf16 v[36:39], v[144:147], v[84:87], 0
    buffer_load_dwordx4 v248, s[12:15], s69 offen offset:2048 sc1 lds
    s_waitcnt vmcnt(12)
    v_mfma_f32_16x16x32_bf16 v[40:43], v[128:131], v[88:91], 0
    v_mfma_f32_16x16x32_bf16 v[44:47], v[132:135], v[88:91], 0
    v_mfma_f32_16x16x32_bf16 v[48:51], v[136:139], v[88:91], 0
    v_mfma_f32_16x16x32_bf16 v[52:55], v[140:143], v[88:91], 0
    buffer_load_dwordx4 v248, s[12:15], s69 offen offset:3072 sc1 lds
    v_mfma_f32_16x16x32_bf16 v[56:59], v[144:147], v[88:91], 0
    s_waitcnt vmcnt(12)
    v_mfma_f32_16x16x32_bf16 v[60:63], v[128:131], v[92:95], 0
    v_mfma_f32_16x16x32_bf16 v[64:67], v[132:135], v[92:95], 0
    v_mfma_f32_16x16x32_bf16 v[68:71], v[136:139], v[92:95], 0
    s_add_u32 m0, s68, 19456
    s_nop 0
    buffer_load_dwordx4 v249, s[12:15], s69 offen sc1 lds
    v_mfma_f32_16x16x32_bf16 v[72:75], v[140:143], v[92:95], 0
    v_mfma_f32_16x16x32_bf16 v[76:79], v[144:147], v[92:95], 0
    s_waitcnt vmcnt(12)
    v_mfma_f32_16x16x32_bf16 v[0:3], v[148:151], v[96:99], v[0:3]
    v_mfma_f32_16x16x32_bf16 v[4:7], v[152:155], v[96:99], v[4:7]
    v_mfma_f32_16x16x32_bf16 v[8:11], v[156:159], v[96:99], v[8:11]
    v_mfma_f32_16x16x32_bf16 v[12:15], v[160:163], v[96:99], v[12:15]
    v_mfma_f32_16x16x32_bf16 v[16:19], v[164:167], v[96:99], v[16:19]
    s_waitcnt vmcnt(11)
    v_mfma_f32_16x16x32_bf16 v[20:23], v[148:151], v[100:103], v[20:23]
    buffer_load_dwordx4 v[80:83], v248, s[12:15], s19 offen offset:0 sc1
    v_mfma_f32_16x16x32_bf16 v[24:27], v[152:155], v[100:103], v[24:27]
    v_mfma_f32_16x16x32_bf16 v[28:31], v[156:159], v[100:103], v[28:31]
    v_mfma_f32_16x16x32_bf16 v[32:35], v[160:163], v[100:103], v[32:35]
    v_mfma_f32_16x16x32_bf16 v[36:39], v[164:167], v[100:103], v[36:39]
    s_waitcnt vmcnt(11)
    v_mfma_f32_16x16x32_bf16 v[40:43], v[148:151], v[104:107], v[40:43]
    buffer_load_dwordx4 v[84:87], v248, s[12:15], s19 offen offset:1024 sc1
    v_mfma_f32_16x16x32_bf16 v[44:47], v[152:155], v[104:107], v[44:47]
    v_mfma_f32_16x16x32_bf16 v[48:51], v[156:159], v[104:107], v[48:51]
    v_mfma_f32_16x16x32_bf16 v[52:55], v[160:163], v[104:107], v[52:55]
    v_mfma_f32_16x16x32_bf16 v[56:59], v[164:167], v[104:107], v[56:59]
    s_waitcnt vmcnt(11)
    v_mfma_f32_16x16x32_bf16 v[60:63], v[148:151], v[108:111], v[60:63]
    buffer_load_dwordx4 v[88:91], v248, s[12:15], s19 offen offset:2048 sc1
    v_mfma_f32_16x16x32_bf16 v[64:67], v[152:155], v[108:111], v[64:67]
    v_mfma_f32_16x16x32_bf16 v[68:71], v[156:159], v[108:111], v[68:71]
    v_mfma_f32_16x16x32_bf16 v[72:75], v[160:163], v[108:111], v[72:75]
    v_mfma_f32_16x16x32_bf16 v[76:79], v[164:167], v[108:111], v[76:79]
    s_waitcnt vmcnt(11)
    v_mfma_f32_16x16x32_bf16 v[0:3], v[168:171], v[112:115], v[0:3]
    buffer_load_dwordx4 v[92:95], v248, s[12:15], s19 offen offset:3072 sc1
    v_mfma_f32_16x16x32_bf16 v[4:7], v[172:175], v[112:115], v[4:7]
    v_mfma_f32_16x16x32_bf16 v[8:11], v[176:179], v[112:115], v[8:11]
    v_mfma_f32_16x16x32_bf16 v[12:15], v[180:183], v[112:115], v[12:15]
    v_mfma_f32_16x16x32_bf16 v[16:19], v[184:187], v[112:115], v[16:19]
    s_waitcnt vmcnt(11)
    v_mfma_f32_16x16x32_bf16 v[20:23], v[168:171], v[116:119], v[20:23]
    buffer_load_dwordx4 v[96:99], v248, s[12:15], s20 offen offset:0 sc1
    v_mfma_f32_16x16x32_bf16 v[24:27], v[172:175], v[116:119], v[24:27]
    v_mfma_f32_16x16x32_bf16 v[28:31], v[176:179], v[116:119], v[28:31]
    v_mfma_f32_16x16x32_bf16 v[32:35], v[180:183], v[116:119], v[32:35]
    v_mfma_f32_16x16x32_bf16 v[36:39], v[184:187], v[116:119], v[36:39]
    s_waitcnt vmcnt(11)
    v_mfma_f32_16x16x32_bf16 v[40:43], v[168:171], v[120:123], v[40:43]
    buffer_load_dwordx4 v[100:103], v248, s[12:15], s20 offen offset:1024 sc1
    v_mfma_f32_16x16x32_bf16 v[44:47], v[172:175], v[120:123], v[44:47]
    v_mfma_f32_16x16x32_bf16 v[48:51], v[176:179], v[120:123], v[48:51]
    ds_read_b32 v255, v253 offset:12
    v_mfma_f32_16x16x32_bf16 v[52:55], v[180:183], v[120:123], v[52:55]
    v_mfma_f32_16x16x32_bf16 v[56:59], v[184:187], v[120:123], v[56:59]
    s_waitcnt vmcnt(11)
    v_mfma_f32_16x16x32_bf16 v[60:63], v[168:171], v[124:127], v[60:63]
    buffer_load_dwordx4 v[104:107], v248, s[12:15], s20 offen offset:2048 sc1
    v_mfma_f32_16x16x32_bf16 v[64:67], v[172:175], v[124:127], v[64:67]
    v_mfma_f32_16x16x32_bf16 v[68:71], v[176:179], v[124:127], v[68:71]
    v_mfma_f32_16x16x32_bf16 v[72:75], v[180:183], v[124:127], v[72:75]
    v_mfma_f32_16x16x32_bf16 v[76:79], v[184:187], v[124:127], v[76:79]
    s_waitcnt vmcnt(6)
    v_mfma_f32_16x16x32_bf16 v[0:3], v[188:191], v[80:83], v[0:3]
    buffer_load_dwordx4 v[108:111], v248, s[12:15], s20 offen offset:3072 sc1
    s_waitcnt lgkmcnt(0)
    v_readfirstlane_b32 s60, v255
    s_cmp_ge_u32 s60, 4
    s_cbranch_scc1 c_nd3
    s_mov_b32 s76, 0
    s_branch lw_42f
lw_42:
    s_sleep 1
    s_add_u32 s76, s76, 1
    s_cmp_gt_u32 s76, 1600000
    s_cbranch_scc1 lx_43
lw_42f:
    ds_read_b32 v255, v253 offset:12
    s_waitcnt lgkmcnt(0)
    v_readfirstlane_b32 s60, v255
    s_cmp_lt_u32 s60, 4
    s_cbranch_scc1 lw_42
lx_43:
c_nd3:
    s_waitcnt vmcnt(13)
    ds_read_b128 v[128:131], v250 offset:0
    v_mfma_f32_16x16x32_bf16 v[4:7], v[192:195], v[80:83], v[4:7]
    v_mfma_f32_16x16x32_bf16 v[8:11], v[196:199], v[80:83], v[8:11]
    ds_read_b128 v[132:135], v250 offset:1024
    v_mfma_f32_16x16x32_bf16 v[12:15], v[200:203], v[80:83], v[12:15]
    ds_read_b128 v[136:139], v250 offset:2048
    v_mfma_f32_16x16x32_bf16 v[16:19], v[204:207], v[80:83], v[16:19]
    s_waitcnt vmcnt(6)
    v_mfma_f32_16x16x32_bf16 v[20:23], v[188:191], v[84:87], v[20:23]
    buffer_load_dwordx4 v[112:115], v248, s[12:15], s21 offen offset:0 sc1
    v_mfma_f32_16x16x32_bf16 v[24:27], v[192:195], v[84:87], v[24:27]
    ds_read_b128 v[140:143], v250 offset:3072
    v_mfma_f32_16x16x32_bf16 v[28:31], v[196:199], v[84:87], v[28:31]
    v_mfma_f32_16x16x32_bf16 v[32:35], v[200:203], v[84:87], v[32:35]
    ds_read_b128 v[144:147], v250 offset:4096
    v_mfma_f32_16x16x32_bf16 v[36:39], v[204:207], v[84:87], v[36:39]
    s_waitcnt vmcnt(6)
    v_mfma_f32_16x16x32_bf16 v[40:43], v[188:191], v[88:91], v[40:43]
    buffer_load_dwordx4 v[116:119], v248, s[12:15], s21 offen offset:1024 sc1
    s_waitcnt vmcnt(15)
    ds_read_b128 v[148:151], v250 offset:5120
    v_mfma_f32_16x16x32_bf16 v[44:47], v[192:195], v[88:91], v[44:47]
    v_mfma_f32_16x16x32_bf16 v[48:51], v[196:199], v[88:91], v[48:51]
    ds_read_b128 v[152:155], v250 offset:6144
    v_mfma_f32_16x16x32_bf16 v[52:55], v[200:203], v[88:91], v[52:55]
    ds_read_b128 v[156:159], v250 offset:7168
    v_mfma_f32_16x16x32_bf16 v[56:59], v[204:207], v[88:91], v[56:59]
    s_waitcnt vmcnt(6)
    v_mfma_f32_16x16x32_bf16 v[60:63], v[188:191], v[92:95], v[60:63]
    buffer_load_dwordx4 v[120:123], v248, s[12:15], s21 offen offset:2048 sc1
    v_mfma_f32_16x16x32_bf16 v[64:67], v[192:195], v[92:95], v[64:67]
    ds_read_b128 v[160:163], v250 offset:8192
    v_mfma_f32_16x16x32_bf16 v[68:71], v[196:199], v[92:95], v[68:71]
    v_mfma_f32_16x16x32_bf16 v[72:75], v[200:203], v[92:95], v[72:75]
    ds_read_b128 v[164:167], v250 offset:9216
    v_mfma_f32_16x16x32_bf16 v[76:79], v[204:207], v[92:95], v[76:79]
    s_waitcnt vmcnt(6)
    v_mfma_f32_16x16x32_bf16 v[0:3], v[208:211], v[96:99], v[0:3]
    buffer_load_dwordx4 v[124:127], v248, s[12:15], s21 offen offset:3072 sc1
    s_waitcnt vmcnt(17)
    ds_read_b128 v[168:171], v251 offset:0
    v_mfma_f32_16x16x32_bf16 v[4:7], v[212:215], v[96:99], v[4:7]
    v_mfma_f32_16x16x32_bf16 v[8:11], v[216:219], v[96:99], v[8:11]
    ds_read_b128 v[172:175], v251 offset:1024
    v_mfma_f32_16x16x32_bf16 v[12:15], v[220:223], v[96:99], v[12:15]
    ds_read_b128 v[176:179], v251 offset:2048
    v_mfma_f32_16x16x32_bf16 v[16:19], v[224:227], v[96:99], v[16:19]
    s_waitcnt vmcnt(6)
    v_mfma_f32_16x16x32_bf16 v[20:23], v[208:211], v[100:103], v[20:23]
    buffer_load_dwordx4 v[80:83], v248, s[12:15], s22 offen offset:0 sc1
    v_mfma_f32_16x16x32_bf16 v[24:27], v[212:215], v[100:103], v[24:27]
    ds_read_b128 v[180:183], v251 offset:3072
    v_mfma_f32_16x16x32_bf16 v[28:31], v[216:219], v[100:103], v[28:31]
    v_mfma_f32_16x16x32_bf16 v[32:35], v[220:223], v[100:103], v[32:35]
    ds_read_b128 v[184:187], v251 offset:4096
    v_mfma_f32_16x16x32_bf16 v[36:39], v[224:227], v[100:103], v[36:39]
    s_waitcnt vmcnt(6)
    v_mfma_f32_16x16x32_bf16 v[40:43], v[208:211], v[104:107], v[40:43]
    buffer_load_dwordx4 v[84:87], v248, s[12:15], s22 offen offset:1024 sc1
    s_waitcnt vmcnt(19)
    ds_read_b128 v[188:191], v251 offset:5120
    v_mfma_f32_16x16x32_bf16 v[44:47], v[212:215], v[104:107], v[44:47]
    v_mfma_f32_16x16x32_bf16 v[48:51], v[216:219], v[104:107], v[48:51]
    ds_read_b128 v[192:195], v251 offset:6144
    v_mfma_f32_16x16x32_bf16 v[52:55], v[220:223], v[104:107], v[52:55]
    ds_read_b128 v[196:199], v251 offset:7168
    v_mfma_f32_16x16x32_bf16 v[56:59], v[224:227], v[104:107], v[56:59]
    s_waitcnt vmcnt(6)
    v_mfma_f32_16x16x32_bf16 v[60:63], v[208:211], v[108:111], v[60:63]
    buffer_load_dwordx4 v[88:91], v248, s[12:15], s22 offen offset:2048 sc1
    v_mfma_f32_16x16x32_bf16 v[64:67], v[212:215], v[108:111], v[64:67]
    ds_read_b128 v[200:203], v251 offset:8192
    v_mfma_f32_16x16x32_bf16 v[68:71], v[216:219], v[108:111], v[68:71]
    v_mfma_f32_16x16x32_bf16 v[72:75], v[220:223], v[108:111], v[72:75]
    ds_read_b128 v[204:207], v251 offset:9216
    v_mfma_f32_16x16x32_bf16 v[76:79], v[224:227], v[108:111], v[76:79]
    s_waitcnt vmcnt(6)
    v_mfma_f32_16x16x32_bf16 v[0:3], v[228:231], v[112:115], v[0:3]
    buffer_load_dwordx4 v[92:95], v248, s[12:15], s22 offen offset:3072 sc1
    s_waitcnt vmcnt(21)
    ds_read_b128 v[208:211], v251 offset:10240
    v_mfma_f32_16x16x32_bf16 v[4:7], v[232:235], v[112:115], v[4:7]
    v_mfma_f32_16x16x32_bf16 v[8:11], v[236:239], v[112:115], v[8:11]
    ds_read_b128 v[212:215], v251 offset:11264
    v_mfma_f32_16x16x32_bf16 v[12:15], v[240:243], v[112:115], v[12:15]
    ds_read_b128 v[216:219], v251 offset:12288
    v_mfma_f32_16x16x32_bf16 v[16:19], v[244:247], v[112:115], v[16:19]
    s_waitcnt vmcnt(6)
    v_mfma_f32_16x16x32_bf16 v[20:23], v[228:231], v[116:119], v[20:23]
    buffer_load_dwordx4 v[96:99], v248, s[12:15], s23 offen offset:0 sc1
    v_mfma_f32_16x16x32_bf16 v[24:27], v[232:235], v[116:119], v[24:27]
    ds_read_b128 v[220:223], v251 offset:13312
    v_mfma_f32_16x16x32_bf16 v[28:31], v[236:239], v[116:119], v[28:31]
    buffer_load_dwordx4 v[100:103], v248, s[12:15], s24 offen offset:0 sc1
    v_mfma_f32_16x16x32_bf16 v[32:35], v[240:243], v[116:119], v[32:35]
    ds_read_b128 v[224:227], v251 offset:14336
    v_mfma_f32_16x16x32_bf16 v[36:39], v[244:247], v[116:119], v[36:39]
    s_waitcnt vmcnt(7)
    v_mfma_f32_16x16x32_bf16 v[40:43], v[228:231], v[120:123], v[40:43]
    buffer_load_dwordx4 v[104:107], v248, s[12:15], s25 offen offset:0 sc1
    v_mfma_f32_16x16x32_bf16 v[44:47], v[232:235], v[120:123], v[44:47]
    v_mfma_f32_16x16x32_bf16 v[48:51], v[236:239], v[120:123], v[48:51]
    buffer_load_dwordx4 v[108:111], v248, s[12:15], s26 offen offset:0 sc1
    v_mfma_f32_16x16x32_bf16 v[52:55], v[240:243], v[120:123], v[52:55]
    v_mfma_f32_16x16x32_bf16 v[56:59], v[244:247], v[120:123], v[56:59]
    s_waitcnt vmcnt(8)
    v_mfma_f32_16x16x32_bf16 v[60:63], v[228:231], v[124:127], v[60:63]
    buffer_load_dwordx4 v[112:115], v248, s[12:15], s27 offen offset:0 sc1
    v_mfma_f32_16x16x32_bf16 v[64:67], v[232:235], v[124:127], v[64:67]
    v_mfma_f32_16x16x32_bf16 v[68:71], v[236:239], v[124:127], v[68:71]
    v_mfma_f32_16x16x32_bf16 v[72:75], v[240:243], v[124:127], v[72:75]
    v_mfma_f32_16x16x32_bf16 v[76:79], v[244:247], v[124:127], v[76:79]
    s_waitcnt vmcnt(8) lgkmcnt(15)
    v_mfma_f32_16x16x32_bf16 v[0:3], v[128:131], v[80:83], v[0:3]
    s_waitcnt vmcnt(21)
    ds_read_b128 v[228:231], v251 offset:15360
    v_mfma_f32_16x16x32_bf16 v[4:7], v[132:135], v[80:83], v[4:7]
    v_mfma_f32_16x16x32_bf16 v[8:11], v[136:139], v[80:83], v[8:11]
    ds_read_b128 v[232:235], v251 offset:16384
    v_mfma_f32_16x16x32_bf16 v[12:15], v[140:143], v[80:83], v[12:15]
    ds_read_b128 v[236:239], v251 offset:17408
    v_mfma_f32_16x16x32_bf16 v[16:19], v[144:147], v[80:83], v[16:19]
    s_waitcnt vmcnt(7)
    v_mfma_f32_16x16x32_bf16 v[20:23], v[128:131], v[84:87], v[20:23]
    v_mfma_f32_16x16x32_bf16 v[24:27], v[132:135], v[84:87], v[24:27]
    ds_read_b128 v[240:243], v251 offset:18432
    v_mfma_f32_16x16x32_bf16 v[28:31], v[136:139], v[84:87], v[28:31]
    v_mfma_f32_16x16x32_bf16 v[32:35], v[140:143], v[84:87], v[32:35]
    ds_read_b128 v[244:247], v251 offset:19456
    v_mfma_f32_16x16x32_bf16 v[36:39], v[144:147], v[84:87], v[36:39]
    s_waitcnt vmcnt(6)
    v_mfma_f32_16x16x32_bf16 v[40:43], v[128:131], v[88:91], v[40:43]
    buffer_load_dwordx4 v[116:119], v248, s[12:15], s23 offen offset:1024 sc1
    v_mfma_f32_16x16x32_bf16 v[44:47], v[132:135], v[88:91], v[44:47]
    v_mfma_f32_16x16x32_bf16 v[48:51], v[136:139], v[88:91], v[48:51]
    buffer_load_dwordx4 v[120:123], v248, s[12:15], s24 offen offset:1024 sc1
    v_mfma_f32_16x16x32_bf16 v[52:55], v[140:143], v[88:91], v[52:55]
    v_mfma_f32_16x16x32_bf16 v[56:59], v[144:147], v[88:91], v[56:59]
    s_waitcnt vmcnt(7)
    v_mfma_f32_16x16x32_bf16 v[60:63], v[128:131], v[92:95], v[60:63]
    buffer_load_dwordx4 v[124:127], v248, s[12:15], s25 offen offset:1024 sc1
    v_mfma_f32_16x16x32_bf16 v[64:67], v[132:135], v[92:95], v[64:67]
    v_mfma_f32_16x16x32_bf16 v[68:71], v[136:139], v[92:95], v[68:71]
    buffer_load_dwordx4 v[80:83], v248, s[12:15], s26 offen offset:1024 sc1
    v_mfma_f32_16x16x32_bf16 v[72:75], v[140:143], v[92:95], v[72:75]
    v_mfma_f32_16x16x32_bf16 v[76:79], v[144:147], v[92:95], v[76:79]
    s_waitcnt vmcnt(8)
    v_mfma_f32_16x16x32_bf16 v[0:3], v[148:151], v[96:99], v[0:3]
    buffer_load_dwordx4 v[84:87], v248, s[12:15], s27 offen offset:1024 sc1
    s_waitcnt vmcnt(8) lgkmcnt(15)
    v_mfma_f32_16x16x32_bf16 v[0:3], v[168:171], v[100:103], v[0:3]
    s_waitcnt vmcnt(7) lgkmcnt(14)
    v_mfma_f32_16x16x32_bf16 v[0:3], v[188:191], v[104:107], v[0:3]
    s_waitcnt vmcnt(6) lgkmcnt(9)
    v_mfma_f32_16x16x32_bf16 v[0:3], v[208:211], v[108:111], v[0:3]
    s_waitcnt vmcnt(5) lgkmcnt(4)
    v_mfma_f32_16x16x32_bf16 v[0:3], v[228:231], v[112:115], v[0:3]
    v_mfma_f32_16x16x32_bf16 v[4:7], v[152:155], v[96:99], v[4:7]
    v_mfma_f32_16x16x32_bf16 v[4:7], v[172:175], v[100:103], v[4:7]
    v_mfma_f32_16x16x32_bf16 v[4:7], v[192:195], v[104:107], v[4:7]
    v_mfma_f32_16x16x32_bf16 v[4:7], v[212:215], v[108:111], v[4:7]
    s_waitcnt lgkmcnt(3)
    v_mfma_f32_16x16x32_bf16 v[4:7], v[232:235], v[112:115], v[4:7]
    v_mfma_f32_16x16x32_bf16 v[8:11], v[156:159], v[96:99], v[8:11]
    v_mfma_f32_16x16x32_bf16 v[8:11], v[176:179], v[100:103], v[8:11]
    v_mfma_f32_16x16x32_bf16 v[8:11], v[196:199], v[104:107], v[8:11]
    ds_write_b128 v252, v[0:3] offset:0
    v_mfma_f32_16x16x32_bf16 v[8:11], v[216:219], v[108:111], v[8:11]
    s_waitcnt lgkmcnt(3)
    v_mfma_f32_16x16x32_bf16 v[8:11], v[236:239], v[112:115], v[8:11]
    v_mfma_f32_16x16x32_bf16 v[12:15], v[160:163], v[96:99], v[12:15]
    buffer_load_dwordx4 v[88:91], v248, s[12:15], s23 offen offset:2048 sc1
    v_mfma_f32_16x16x32_bf16 v[12:15], v[180:183], v[100:103], v[12:15]
    v_mfma_f32_16x16x32_bf16 v[12:15], v[200:203], v[104:107], v[12:15]
    buffer_load_dwordx4 v[92:95], v248, s[12:15], s24 offen offset:2048 sc1
    ds_write_b128 v252, v[4:7] offset:64
    v_mfma_f32_16x16x32_bf16 v[12:15], v[220:223], v[108:111], v[12:15]
    s_waitcnt lgkmcnt(3)
    v_mfma_f32_16x16x32_bf16 v[12:15], v[240:243], v[112:115], v[12:15]
    v_mfma_f32_16x16x32_bf16 v[16:19], v[164:167], v[96:99], v[16:19]
    v_mfma_f32_16x16x32_bf16 v[16:19], v[184:187], v[100:103], v[16:19]
    buffer_load_dwordx4 v[96:99], v248, s[12:15], s25 offen offset:2048 sc1
    v_mfma_f32_16x16x32_bf16 v[16:19], v[204:207], v[104:107], v[16:19]
    ds_write_b128 v252, v[8:11] offset:128
    v_mfma_f32_16x16x32_bf16 v[16:19], v[224:227], v[108:111], v[16:19]
    buffer_load_dwordx4 v[100:103], v248, s[12:15], s26 offen offset:2048 sc1
    s_waitcnt lgkmcnt(3)
    v_mfma_f32_16x16x32_bf16 v[16:19], v[244:247], v[112:115], v[16:19]
    s_waitcnt vmcnt(8)
    v_mfma_f32_16x16x32_bf16 v[20:23], v[148:151], v[116:119], v[20:23]
    buffer_load_dwordx4 v[104:107], v248, s[12:15], s27 offen offset:2048 sc1
    s_waitcnt vmcnt(8)
    v_mfma_f32_16x16x32_bf16 v[20:23], v[168:171], v[120:123], v[20:23]
    s_waitcnt vmcnt(7)
    v_mfma_f32_16x16x32_bf16 v[20:23], v[188:191], v[124:127], v[20:23]
    ds_write_b128 v252, v[12:15] offset:192
    s_waitcnt vmcnt(6)
    v_mfma_f32_16x16x32_bf16 v[20:23], v[208:211], v[80:83], v[20:23]
    s_waitcnt vmcnt(5)
    v_mfma_f32_16x16x32_bf16 v[20:23], v[228:231], v[84:87], v[20:23]
    v_mfma_f32_16x16x32_bf16 v[24:27], v[152:155], v[116:119], v[24:27]
    v_mfma_f32_16x16x32_bf16 v[24:27], v[172:175], v[120:123], v[24:27]
    v_mfma_f32_16x16x32_bf16 v[24:27], v[192:195], v[124:127], v[24:27]
    ds_write_b128 v252, v[16:19] offset:256
    v_mfma_f32_16x16x32_bf16 v[24:27], v[212:215], v[80:83], v[24:27]
    v_mfma_f32_16x16x32_bf16 v[24:27], v[232:235], v[84:87], v[24:27]
    v_mfma_f32_16x16x32_bf16 v[28:31], v[156:159], v[116:119], v[28:31]
    v_mfma_f32_16x16x32_bf16 v[28:31], v[176:179], v[120:123], v[28:31]
    v_mfma_f32_16x16x32_bf16 v[28:31], v[196:199], v[124:127], v[28:31]
    ds_write_b128 v252, v[20:23] offset:5376
    v_mfma_f32_16x16x32_bf16 v[28:31], v[216:219], v[80:83], v[28:31]
    v_mfma_f32_16x16x32_bf16 v[28:31], v[236:239], v[84:87], v[28:31]
    v_mfma_f32_16x16x32_bf16 v[32:35], v[160:163], v[116:119], v[32:35]
    buffer_load_dwordx4 v[108:111], v248, s[12:15], s23 offen offset:3072 sc1
    v_mfma_f32_16x16x32_bf16 v[32:35], v[180:183], v[120:123], v[32:35]
    v_mfma_f32_16x16x32_bf16 v[32:35], v[200:203], v[124:127], v[32:35]
    buffer_load_dwordx4 v[112:115], v248, s[12:15], s24 offen offset:3072 sc1
    ds_write_b128 v252, v[24:27] offset:5440
    v_mfma_f32_16x16x32_bf16 v[32:35], v[220:223], v[80:83], v[32:35]
    v_mfma_f32_16x16x32_bf16 v[32:35], v[240:243], v[84:87], v[32:35]
    v_mfma_f32_16x16x32_bf16 v[36:39], v[164:167], v[116:119], v[36:39]
    v_mfma_f32_16x16x32_bf16 v[36:39], v[184:187], v[120:123], v[36:39]
    buffer_load_dwordx4 v[116:119], v248, s[12:15], s25 offen offset:3072 sc1
    v_mfma_f32_16x16x32_bf16 v[36:39], v[204:207], v[124:127], v[36:39]
    ds_write_b128 v252, v[28:31] offset:5504
    v_mfma_f32_16x16x32_bf16 v[36:39], v[224:227], v[80:83], v[36:39]
    buffer_load_dwordx4 v[120:123], v248, s[12:15], s26 offen offset:3072 sc1
    v_mfma_f32_16x16x32_bf16 v[36:39], v[244:247], v[84:87], v[36:39]
    s_waitcnt vmcnt(8)
    v_mfma_f32_16x16x32_bf16 v[40:43], v[148:151], v[88:91], v[40:43]
    buffer_load_dwordx4 v[124:127], v248, s[12:15], s27 offen offset:3072 sc1
    s_waitcnt vmcnt(8)
    v_mfma_f32_16x16x32_bf16 v[40:43], v[168:171], v[92:95], v[40:43]
    s_waitcnt vmcnt(7)
    v_mfma_f32_16x16x32_bf16 v[40:43], v[188:191], v[96:99], v[40:43]
    ds_write_b128 v252, v[32:35] offset:5568
    s_waitcnt vmcnt(6)
    v_mfma_f32_16x16x32_bf16 v[40:43], v[208:211], v[100:103], v[40:43]
    s_waitcnt vmcnt(5)
    v_mfma_f32_16x16x32_bf16 v[40:43], v[228:231], v[104:107], v[40:43]
    v_mfma_f32_16x16x32_bf16 v[44:47], v[152:155], v[88:91], v[44:47]
    v_mfma_f32_16x16x32_bf16 v[44:47], v[172:175], v[92:95], v[44:47]
    v_mfma_f32_16x16x32_bf16 v[44:47], v[192:195], v[96:99], v[44:47]
    ds_write_b128 v252, v[36:39] offset:5632
    s_mov_b64 exec, 1
    ds_add_u32 v253, v254 offset:20
    s_mov_b64 exec, -1
    v_mfma_f32_16x16x32_bf16 v[44:47], v[212:215], v[100:103], v[44:47]
    v_mfma_f32_16x16x32_bf16 v[44:47], v[232:235], v[104:107], v[44:47]
    v_mfma_f32_16x16x32_bf16 v[48:51], v[156:159], v[88:91], v[48:51]
    v_mfma_f32_16x16x32_bf16 v[48:51], v[176:179], v[92:95], v[48:51]
    v_mfma_f32_16x16x32_bf16 v[48:51], v[196:199], v[96:99], v[48:51]
    ds_write_b128 v252, v[40:43] offset:10752
    v_mfma_f32_16x16x32_bf16 v[48:51], v[216:219], v[100:103], v[48:51]
    v_mfma_f32_16x16x32_bf16 v[48:51], v[236:239], v[104:107], v[48:51]
    v_mfma_f32_16x16x32_bf16 v[52:55], v[160:163], v[88:91], v[52:55]
    v_mfma_f32_16x16x32_bf16 v[52:55], v[180:183], v[92:95], v[52:55]
    v_mfma_f32_16x16x32_bf16 v[52:55], v[200:203], v[96:99], v[52:55]
    ds_write_b128 v252, v[44:47] offset:10816
    v_mfma_f32_16x16x32_bf16 v[52:55], v[220:223], v[100:103], v[52:55]
    v_mfma_f32_16x16x32_bf16 v[52:55], v[240:243], v[104:107], v[52:55]
    v_mfma_f32_16x16x32_bf16 v[56:59], v[164:167], v[88:91], v[56:59]
    v_mfma_f32_16x16x32_bf16 v[56:59], v[184:187], v[92:95], v[56:59]
    v_mfma_f32_16x16x32_bf16 v[56:59], v[204:207], v[96:99], v[56:59]
    ds_write_b128 v252, v[48:51] offset:10880
    v_mfma_f32_16x16x32_bf16 v[56:59], v[224:227], v[100:103], v[56:59]
    v_mfma_f32_16x16x32_bf16 v[56:59], v[244:247], v[104:107], v[56:59]
    s_waitcnt vmcnt(4)
    v_mfma_f32_16x16x32_bf16 v[60:63], v[148:151], v[108:111], v[60:63]
    s_waitcnt vmcnt(3)
    v_mfma_f32_16x16x32_bf16 v[60:63], v[168:171], v[112:115], v[60:63]
    s_waitcnt vmcnt(2)
    v_mfma_f32_16x16x32_bf16 v[60:63], v[188:191], v[116:119], v[60:63]
    ds_write_b128 v252, v[52:55] offset:10944
    s_waitcnt vmcnt(1)
    v_mfma_f32_16x16x32_bf16 v[60:63], v[208:211], v[120:123], v[60:63]
    s_waitcnt vmcnt(0)
    v_mfma_f32_16x16x32_bf16 v[60:63], v[228:231], v[124:127], v[60:63]
    v_mfma_f32_16x16x32_bf16 v[64:67], v[152:155], v[108:111], v[64:67]
    v_mfma_f32_16x16x32_bf16 v[64:67], v[172:175], v[112:115], v[64:67]
    v_mfma_f32_16x16x32_bf16 v[64:67], v[192:195], v[116:119], v[64:67]
    ds_write_b128 v252, v[56:59] offset:11008
    s_mov_b64 exec, 1
    ds_add_u32 v253, v254 offset:24
    s_mov_b64 exec, -1
    v_mfma_f32_16x16x32_bf16 v[64:67], v[212:215], v[120:123], v[64:67]
    v_mfma_f32_16x16x32_bf16 v[64:67], v[232:235], v[124:127], v[64:67]
    v_mfma_f32_16x16x32_bf16 v[68:71], v[156:159], v[108:111], v[68:71]
    v_mfma_f32_16x16x32_bf16 v[68:71], v[176:179], v[112:115], v[68:71]
    v_mfma_f32_16x16x32_bf16 v[68:71], v[196:199], v[116:119], v[68:71]
    ds_write_b128 v252, v[60:63] offset:16128
    v_mfma_f32_16x16x32_bf16 v[68:71], v[216:219], v[120:123], v[68:71]
    v_mfma_f32_16x16x32_bf16 v[68:71], v[236:239], v[124:127], v[68:71]
    v_mfma_f32_16x16x32_bf16 v[72:75], v[160:163], v[108:111], v[72:75]
    v_mfma_f32_16x16x32_bf16 v[72:75], v[180:183], v[112:115], v[72:75]
    v_mfma_f32_16x16x32_bf16 v[72:75], v[200:203], v[116:119], v[72:75]
    ds_write_b128 v252, v[64:67] offset:16192
    v_mfma_f32_16x16x32_bf16 v[72:75], v[220:223], v[120:123], v[72:75]
    v_mfma_f32_16x16x32_bf16 v[72:75], v[240:243], v[124:127], v[72:75]
    v_mfma_f32_16x16x32_bf16 v[76:79], v[164:167], v[108:111], v[76:79]
    v_mfma_f32_16x16x32_bf16 v[76:79], v[184:187], v[112:115], v[76:79]
    v_mfma_f32_16x16x32_bf16 v[76:79], v[204:207], v[116:119], v[76:79]
    ds_write_b128 v252, v[68:71] offset:16256
    v_mfma_f32_16x16x32_bf16 v[76:79], v[224:227], v[120:123], v[76:79]
    v_mfma_f32_16x16x32_bf16 v[76:79], v[244:247], v[124:127], v[76:79]
    s_nop 1
    ds_write_b128 v252, v[72:75] offset:16320
    s_nop 4
    ds_write_b128 v252, v[76:79] offset:16384
    s_mov_b64 exec, 1
    ds_add_u32 v253, v254 offset:28
    s_mov_b64 exec, -1
    s_endpgm
k_end:
    s_endpgm
.section .rodata,"a"
.p2align 6
.amdhsa_kernel parallel_sum__ssm_conv_s4__mixer_channel_mlp__prompt_kernel
  .amdhsa_next_free_vgpr 256
  .amdhsa_next_free_sgpr 102
  .amdhsa_accum_offset 256
  .amdhsa_group_segment_fixed_size 0
  .amdhsa_kernarg_size 136
  .amdhsa_user_sgpr_count 2
  .amdhsa_user_sgpr_kernarg_segment_ptr 1
  .amdhsa_system_sgpr_workgroup_id_x 1
.end_amdhsa_kernel
```
